```python
import torch

def _softmax(x, axis=-1):
    return torch.softmax(x, dim=axis)
def _gelu(x):
    return torch.nn.functional.gelu(x, approximate="tanh")
def _silu(x):
    return torch.nn.functional.silu(x)
def _sigmoid(x):
    return torch.sigmoid(x)
def _layernorm(x, axis=-1, eps=1e-5):
    m = x.mean(dim=axis, keepdim=True)
    v = x.var(dim=axis, keepdim=True, unbiased=False)
    return (x - m) / torch.sqrt(v + eps)
def _scatter_add(tgt, idx, src, axis=0):
    return tgt.clone().index_add_(axis, idx, src)
def _segment_sum(src, seg, n):
    out = torch.zeros((n,) + src.shape[1:], dtype=src.dtype)
    return out.index_add_(0, seg, src)
def _pad(x, pw):
    flat = tuple(v for pair in reversed(pw) for v in pair)
    return torch.nn.functional.pad(x, flat)

kernel_name = 'gather_scatter__mpnn_edge_mlp__graph'

def setup_inputs():

    _w = (lambda a: (lambda t: t.to(torch.bfloat16) if t.is_floating_point() else t)(torch.as_tensor(a)))
    N, deg, D, De = 12500, 64, 64, max(0, 1)
    E = N * deg
    return {
        "x": _w((lambda *s: torch.randn(*s, dtype=torch.bfloat16) * 0.05)(N, D)),
        "e_attr": _w((lambda *s: torch.randn(*s, dtype=torch.bfloat16) * 0.4)(E, De)),
        "src": _w((lambda lo, hi, *s: torch.randint(lo, hi, s))(0, N, E).to(torch.int64)),
        "dst": _w((lambda lo, hi, *s: torch.randint(lo, hi, s))(0, N, E).to(torch.int64)),
        "w_msg": _w((lambda *s: torch.randn(*s, dtype=torch.bfloat16) * 0.4)(2 * D + De, D)),
        "w_upd": _w((lambda *s: torch.randn(*s, dtype=torch.bfloat16) * 0.05)(2 * D, D)),
    }

def reference(x, e_attr, src, dst, w_msg, w_upd):
    N, D = x.shape
    m_in = torch.concatenate([x[src], x[dst], e_attr], axis=-1)
    msg = _silu(m_in @ w_msg)
    agg = _segment_sum(msg, dst, N)
    return _silu(torch.concatenate([x, agg], axis=-1) @ w_upd)
```

```asm
; @launch grid=(256,1,1) block=(1024,1,1) lds=160768
.amdgcn_target "amdgcn-amd-amdhsa--gfx950"
.text
.globl gather_scatter__mpnn_edge_mlp__graph_kernel
.p2align 8
.type gather_scatter__mpnn_edge_mlp__graph_kernel,@function
gather_scatter__mpnn_edge_mlp__graph_kernel:
    v_readfirstlane_b32 s4, v0
    s_load_dwordx16 s[24:39], s[0:1], 0
    s_load_dwordx2 s[8:9], s[0:1], 64
    s_cmp_ge_u32 s2, 256
    s_cbranch_scc1 L_k2_end
    s_cmp_lt_u32 s4, 128
    s_cbranch_scc1 L_auxpf
    s_and_b32 s3, s2, 7
    s_lshl_b32 s3, s3, 5
    s_lshr_b32 s64, s2, 3
    s_add_u32 s3, s3, s64
    s_sub_u32 s3, 255, s3
    s_mul_i32 s5, s3, 6272
    s_lshr_b32 s4, s4, 6
    v_lshlrev_b32 v25, 2, v0
    v_mov_b32 v24, 0
    ds_write_b32 v25, v24 offset:16896
    s_cmp_lt_u32 s4, 6
    s_cbranch_scc1 L_p
    s_cmp_ge_u32 s3, 250
    s_cbranch_scc1 L_idle
    s_mul_i32 s40, s3, 12800
    s_sub_u32 s41, s40, 6144
    s_add_u32 s42, s40, 8704
    v_lshl_add_u32 v10, v0, 4, s41
    v_add_u32 v11, s42, v25
    v_lshrrev_b32 v2, 1, v10
    v_lshrrev_b32 v3, 1, v11
    s_waitcnt lgkmcnt(0)
    global_load_dwordx4 v[4:7], v10, s[30:31]
    global_load_dword v8, v11, s[30:31]
    global_load_dwordx4 v[12:15], v10, s[28:29]
    global_load_dwordx2 v[20:21], v2, s[26:27]
    global_load_dword v16, v11, s[28:29]
    global_load_ushort v22, v3, s[26:27]
    s_branch L_edge
L_auxpf:
    s_cmp_ge_u32 s2, 64
    s_cbranch_scc1 L_auxpf1
    s_getpc_b64 s[40:41]
    s_lshr_b32 s42, s2, 3
    s_mul_i32 s42, s42, 1280
    s_mul_i32 s43, s4, 10
    s_add_u32 s42, s42, s43
    s_add_u32 s40, s40, s42
    s_addc_u32 s41, s41, 0
    s_load_dword s42, s[40:41], 64
    s_load_dword s43, s[40:41], 128
    s_load_dword s44, s[40:41], 192
    s_load_dword s45, s[40:41], 256
    s_load_dword s46, s[40:41], 320
    s_load_dword s47, s[40:41], 384
    s_load_dword s48, s[40:41], 448
    s_load_dword s49, s[40:41], 512
    s_load_dword s50, s[40:41], 576
    s_load_dword s51, s[40:41], 640
L_auxpf1:
    s_barrier
    s_branch L_aux
L_p:
    v_subrev_u32 v80, 128, v0
    v_lshlrev_b32 v1, 4, v80
    s_add_u32 s40, s5, 6384
    s_min_u32 s40, s40, 1599984
    v_add_u32 v2, s5, v1
    v_add_u32 v3, 4096, v2
    v_min_u32 v2, s40, v2
    v_min_u32 v3, s40, v3
    v_add_u32 v4, 4096, v1
    v_add_u32 v5, 12288, v1
    s_waitcnt lgkmcnt(0)
    global_load_dwordx4 v[40:43], v2, s[24:25]
    global_load_dwordx4 v[44:47], v3, s[24:25]
    global_load_dwordx4 v[24:27], v4, s[32:33] offset:-4096
    global_load_dwordx4 v[28:31], v4, s[32:33]
    global_load_dwordx4 v[32:35], v5, s[32:33] offset:-4096
    global_load_dwordx4 v[36:39], v5, s[32:33]
    s_barrier
    s_add_u32 s16, s8, 6291456
    s_addc_u32 s17, s9, 0
    s_mov_b32 s18, 18944000
    s_mov_b32 s19, 0x20000
    s_mov_b32 s11, 0x20000
    v_lshrrev_b32 v2, 3, v80
    v_and_b32 v3, 0x70, v1
    v_mul_u32_u24 v4, 192, v2
    v_add_u32 v4, v4, v3
    v_mul_u32_u24 v5, 144, v2
    v_add_u32 v5, v5, v3
    v_add_u32 v5, 133120, v5
    v_bfe_u32 v6, v0, 5, 1
    v_bfe_u32 v7, v0, 2, 2
    v_lshl_add_u32 v8, v6, 3, v7
    v_mul_u32_u24 v8, 192, v8
    v_bfe_u32 v9, v0, 4, 1
    v_and_b32 v10, 3, v0
    v_lshl_add_u32 v11, v9, 2, v10
    s_lshr_b32 s45, s4, 2
    s_and_b32 s46, s4, 1
    s_sub_u32 s47, 4, s45
    v_lshlrev_b32 v11, s47, v11
    s_mul_i32 s47, s45, 92160
    v_add3_u32 v8, v8, v11, s47
    s_mul_i32 s47, s45, 56
    s_add_u32 s47, s47, 8
    v_add_u32 v12, s47, v8
    v_and_b32 v13, 31, v0
    v_mul_u32_u24 v14, 144, v13
    v_lshl_add_u32 v14, v6, 4, v14
    s_mul_i32 s47, s46, 4608
    s_add_u32 s47, s47, 133120
    v_add_u32 v14, s47, v14
    s_mov_b32 s48, 0xbfb8aa3b
    v_add_u32 v17, 92160, v4
    v_mov_b32 v15, 0
    v_mov_b32 v16, 1
    s_setprio 2
    s_waitcnt vmcnt(5)
    ds_write_b128 v5, v[40:43]
    s_waitcnt vmcnt(4)
    ds_write_b128 v5, v[44:47] offset:4608
    s_waitcnt vmcnt(3)
    ds_write_b128 v4, v[24:27] offset:27136
    s_waitcnt vmcnt(2)
    ds_write_b128 v4, v[28:31] offset:33280
    s_waitcnt vmcnt(1)
    ds_write_b128 v17, v[32:35] offset:27136
    s_waitcnt vmcnt(0)
    ds_write_b128 v17, v[36:39] offset:33280
    s_mov_b64 exec, 1
    ds_add_u32 v15, v16 offset:20480
L_pmeet:
    ds_read_b32 v16, v15 offset:20480
    s_waitcnt lgkmcnt(0)
    v_cmp_gt_u32 vcc, 4, v16
    s_cbranch_vccnz L_pmeet
    s_mov_b64 exec, -1
    ds_read_b128 v[16:19], v14 offset:0
    ds_read_b64_tr_b16 v[20:21], v8 offset:27136
    ds_read_b64_tr_b16 v[22:23], v8 offset:27904
    ds_read_b64_tr_b16 v[24:25], v12 offset:27136
    ds_read_b64_tr_b16 v[26:27], v12 offset:27904
    ds_read_b128 v[28:31], v14 offset:32
    ds_read_b64_tr_b16 v[32:33], v8 offset:30208
    ds_read_b64_tr_b16 v[34:35], v8 offset:30976
    ds_read_b64_tr_b16 v[36:37], v12 offset:30208
    ds_read_b64_tr_b16 v[38:39], v12 offset:30976
    ds_read_b128 v[40:43], v14 offset:64
    ds_read_b64_tr_b16 v[44:45], v8 offset:33280
    ds_read_b64_tr_b16 v[46:47], v8 offset:34048
    ds_read_b64_tr_b16 v[48:49], v12 offset:33280
    ds_read_b64_tr_b16 v[50:51], v12 offset:34048
    s_waitcnt lgkmcnt(10)
    v_mfma_f32_32x32x16_bf16 v[64:79], v[16:19], v[20:23], 0
    v_mfma_f32_32x32x16_bf16 v[92:107], v[16:19], v[24:27], 0
    ds_read_b128 v[52:55], v14 offset:96
    ds_read_b64_tr_b16 v[56:57], v8 offset:36352
    ds_read_b64_tr_b16 v[58:59], v8 offset:37120
    ds_read_b64_tr_b16 v[60:61], v12 offset:36352
    ds_read_b64_tr_b16 v[62:63], v12 offset:37120
    s_waitcnt lgkmcnt(10)
    v_mfma_f32_32x32x16_bf16 v[64:79], v[28:31], v[32:35], v[64:79]
    v_mfma_f32_32x32x16_bf16 v[92:107], v[28:31], v[36:39], v[92:107]
    s_waitcnt lgkmcnt(5)
    v_mfma_f32_32x32x16_bf16 v[64:79], v[40:43], v[44:47], v[64:79]
    v_mfma_f32_32x32x16_bf16 v[92:107], v[40:43], v[48:51], v[92:107]
    s_waitcnt lgkmcnt(0)
    v_mfma_f32_32x32x16_bf16 v[64:79], v[52:55], v[56:59], v[64:79]
    v_mfma_f32_32x32x16_bf16 v[92:107], v[52:55], v[60:63], v[92:107]
    s_add_u32 s6, s8, 5505024
    s_addc_u32 s7, s9, 0
    s_load_dwordx2 s[38:39], s[6:7], 0
    s_cmp_eq_u32 s45, 0
    s_cbranch_scc0 L_q
    s_add_u32 s40, s5, 6272
    s_min_u32 s10, s40, 1600000
    s_lshl_b32 s46, s46, 12
    s_add_u32 s46, s46, s5
    v_lshlrev_b32 v2, 6, v9
    v_lshl_add_u32 v2, v10, 4, v2
    v_lshl_add_u32 v2, v7, 2, v2
    v_lshl_add_u32 v2, v6, 9, v2
    s_nop 3
    v_mul_f32 v64, s48, v64
    v_mul_f32 v92, s48, v92
    v_cvt_pk_bf16_f32 v64, v64, v92
    buffer_store_dword v64, v2, s[8:11], s46 offen offset:0 sc1
    v_mul_f32 v65, s48, v65
    v_mul_f32 v93, s48, v93
    v_cvt_pk_bf16_f32 v65, v65, v93
    buffer_store_dword v65, v2, s[8:11], s46 offen offset:128 sc1
    v_mul_f32 v66, s48, v66
    v_mul_f32 v94, s48, v94
    v_cvt_pk_bf16_f32 v66, v66, v94
    buffer_store_dword v66, v2, s[8:11], s46 offen offset:256 sc1
    v_mul_f32 v67, s48, v67
    v_mul_f32 v95, s48, v95
    v_cvt_pk_bf16_f32 v67, v67, v95
    buffer_store_dword v67, v2, s[8:11], s46 offen offset:384 sc1
    v_mul_f32 v68, s48, v68
    v_mul_f32 v96, s48, v96
    v_cvt_pk_bf16_f32 v68, v68, v96
    buffer_store_dword v68, v2, s[8:11], s46 offen offset:1024 sc1
    v_mul_f32 v69, s48, v69
    v_mul_f32 v97, s48, v97
    v_cvt_pk_bf16_f32 v69, v69, v97
    buffer_store_dword v69, v2, s[8:11], s46 offen offset:1152 sc1
    v_mul_f32 v70, s48, v70
    v_mul_f32 v98, s48, v98
    v_cvt_pk_bf16_f32 v70, v70, v98
    buffer_store_dword v70, v2, s[8:11], s46 offen offset:1280 sc1
    v_mul_f32 v71, s48, v71
    v_mul_f32 v99, s48, v99
    v_cvt_pk_bf16_f32 v71, v71, v99
    buffer_store_dword v71, v2, s[8:11], s46 offen offset:1408 sc1
    v_mul_f32 v72, s48, v72
    v_mul_f32 v100, s48, v100
    v_cvt_pk_bf16_f32 v72, v72, v100
    buffer_store_dword v72, v2, s[8:11], s46 offen offset:2048 sc1
    v_mul_f32 v73, s48, v73
    v_mul_f32 v101, s48, v101
    v_cvt_pk_bf16_f32 v73, v73, v101
    buffer_store_dword v73, v2, s[8:11], s46 offen offset:2176 sc1
    v_mul_f32 v74, s48, v74
    v_mul_f32 v102, s48, v102
    v_cvt_pk_bf16_f32 v74, v74, v102
    buffer_store_dword v74, v2, s[8:11], s46 offen offset:2304 sc1
    v_mul_f32 v75, s48, v75
    v_mul_f32 v103, s48, v103
    v_cvt_pk_bf16_f32 v75, v75, v103
    buffer_store_dword v75, v2, s[8:11], s46 offen offset:2432 sc1
    v_mul_f32 v76, s48, v76
    v_mul_f32 v104, s48, v104
    v_cvt_pk_bf16_f32 v76, v76, v104
    buffer_store_dword v76, v2, s[8:11], s46 offen offset:3072 sc1
    v_mul_f32 v77, s48, v77
    v_mul_f32 v105, s48, v105
    v_cvt_pk_bf16_f32 v77, v77, v105
    buffer_store_dword v77, v2, s[8:11], s46 offen offset:3200 sc1
    v_mul_f32 v78, s48, v78
    v_mul_f32 v106, s48, v106
    v_cvt_pk_bf16_f32 v78, v78, v106
    buffer_store_dword v78, v2, s[8:11], s46 offen offset:3328 sc1
    v_mul_f32 v79, s48, v79
    v_mul_f32 v107, s48, v107
    v_cvt_pk_bf16_f32 v79, v79, v107
    buffer_store_dword v79, v2, s[8:11], s46 offen offset:3456 sc1
    s_branch L_third
L_q:
    s_lshl_b32 s46, s46, 13
    v_lshlrev_b32 v2, 2, v13
    v_lshl_add_u32 v2, v6, 10, v2
    v_add_u32 v2, s46, v2
    s_nop 7
    v_mul_f32 v64, s48, v64
    v_mul_f32 v92, s48, v92
    ds_write_b32 v2, v64 offset:1024
    ds_write_b32 v2, v92 offset:1152
    v_mul_f32 v65, s48, v65
    v_mul_f32 v93, s48, v93
    ds_write_b32 v2, v65 offset:1280
    ds_write_b32 v2, v93 offset:1408
    v_mul_f32 v66, s48, v66
    v_mul_f32 v94, s48, v94
    ds_write_b32 v2, v66 offset:1536
    ds_write_b32 v2, v94 offset:1664
    v_mul_f32 v67, s48, v67
    v_mul_f32 v95, s48, v95
    ds_write_b32 v2, v67 offset:1792
    ds_write_b32 v2, v95 offset:1920
    v_mul_f32 v68, s48, v68
    v_mul_f32 v96, s48, v96
    ds_write_b32 v2, v68 offset:3072
    ds_write_b32 v2, v96 offset:3200
    v_mul_f32 v69, s48, v69
    v_mul_f32 v97, s48, v97
    ds_write_b32 v2, v69 offset:3328
    ds_write_b32 v2, v97 offset:3456
    v_mul_f32 v70, s48, v70
    v_mul_f32 v98, s48, v98
    ds_write_b32 v2, v70 offset:3584
    ds_write_b32 v2, v98 offset:3712
    v_mul_f32 v71, s48, v71
    v_mul_f32 v99, s48, v99
    ds_write_b32 v2, v71 offset:3840
    ds_write_b32 v2, v99 offset:3968
    v_mul_f32 v72, s48, v72
    v_mul_f32 v100, s48, v100
    ds_write_b32 v2, v72 offset:5120
    ds_write_b32 v2, v100 offset:5248
    v_mul_f32 v73, s48, v73
    v_mul_f32 v101, s48, v101
    ds_write_b32 v2, v73 offset:5376
    ds_write_b32 v2, v101 offset:5504
    v_mul_f32 v74, s48, v74
    v_mul_f32 v102, s48, v102
    ds_write_b32 v2, v74 offset:5632
    ds_write_b32 v2, v102 offset:5760
    v_mul_f32 v75, s48, v75
    v_mul_f32 v103, s48, v103
    ds_write_b32 v2, v75 offset:5888
    ds_write_b32 v2, v103 offset:6016
    v_mul_f32 v76, s48, v76
    v_mul_f32 v104, s48, v104
    ds_write_b32 v2, v76 offset:7168
    ds_write_b32 v2, v104 offset:7296
    v_mul_f32 v77, s48, v77
    v_mul_f32 v105, s48, v105
    ds_write_b32 v2, v77 offset:7424
    ds_write_b32 v2, v105 offset:7552
    v_mul_f32 v78, s48, v78
    v_mul_f32 v106, s48, v106
    ds_write_b32 v2, v78 offset:7680
    ds_write_b32 v2, v106 offset:7808
    v_mul_f32 v79, s48, v79
    v_mul_f32 v107, s48, v107
    ds_write_b32 v2, v79 offset:7936
    ds_write_b32 v2, v107 offset:8064
L_third:
    v_lshlrev_b32 v2, 2, v80
    v_and_b32 v3, 0x70, v1
    v_add_u32 v4, 40544, v3
    v_bfe_u32 v7, v0, 3, 3
    s_lshl_b32 s42, s4, 8
    v_lshl_add_u32 v8, v7, 2, s42
    s_mul_i32 s40, s3, 75776
    s_add_u32 s40, s40, 24576
    s_mov_b32 s41, 196614
    s_movk_i32 s43, 208
    v_mov_b32 v9, 0x00fcfcfc
    s_setprio 0
    s_waitcnt lgkmcnt(0)
    s_mul_i32 s38, s38, 1664525
    s_add_u32 s38, s38, 1013904223
    s_add_u32 s39, s39, 1
    s_and_b32 s6, s39, 63
    s_mul_i32 s6, s6, 0x1041
    s_and_b32 s6, s6, 0x030303
    s_lshl_b32 s7, s39, 18
    s_and_b32 s7, s7, 0xff000000
    s_or_b32 s24, s6, s7
    s_and_b32 s25, s39, 0xc0c0c0c0
    s_or_b32 s25, s25, 0x40
    s_mov_b32 s26, s38
    s_mov_b32 s27, s39
    s_barrier
    ds_read_b32 v5, v2 offset:17408
    s_waitcnt vmcnt(0) lgkmcnt(0)
    v_cmp_lt_u32 vcc, s41, v5
    s_cbranch_vccz L_common
    s_bcnt1_i32_b64 s44, vcc
    v_mbcnt_lo_u32_b32 v6, vcc_lo, 0
    v_mbcnt_hi_u32_b32 v6, vcc_hi, v6
    v_lshl_add_u32 v6, v6, 2, s42
    s_mov_b64 exec, vcc
    ds_write_b32 v6, v80 offset:18944
L_third1:
    s_mov_b64 exec, -1
    v_cmp_gt_i32 vcc, s44, v7
    s_mov_b64 exec, vcc
    ds_read_b32 v5, v8 offset:18944
    v_add_u32 v8, 32, v8
    s_sub_u32 s44, s44, 8
    s_waitcnt lgkmcnt(0)
    v_mad_u32_u24 v6, v5, s43, v4
    ds_read_b128 v[16:19], v6
    v_lshl_add_u32 v5, v5, 7, v3
    s_cmp_gt_i32 s44, 0
    s_waitcnt lgkmcnt(0)
    v_and_or_b32 v19, v19, v9, s24
    buffer_store_dwordx4 v[16:19], v5, s[16:19], s40 offen sc1
    s_cbranch_scc1 L_third1
    s_mov_b64 exec, -1
    s_branch L_common
L_edge:
    s_barrier
    s_add_u32 s16, s8, 6291456
    s_addc_u32 s17, s9, 0
    s_mov_b32 s18, 18944000
    s_mov_b32 s19, 0x20000
    s_mul_i32 s40, s3, 75776
    s_add_u32 s41, s40, 9216
    s_add_u32 s42, s40, 18432
    s_mov_b32 s45, 4294967100
    s_mov_b32 s46, 0xffff0000
    s_mov_b32 s47, 393216
    s_mov_b32 s48, 40448
    v_mov_b32 v3, 10923
    v_subrev_u32 v9, 384, v0
    v_lshlrev_b32 v1, 4, v9
    v_mul_u32_u24 v26, 10923, v9
    v_lshrrev_b32 v26, 16, v26
    v_mul_u32_u24 v26, 112, v26
    v_add3_u32 v62, v26, v1, s48
    v_mov_b32 v63, 0x00fcfcfc
    v_mov_b32 v56, 65535
    v_mov_b32 v57, 65535
    v_mov_b32 v58, 65535
    v_mov_b32 v59, 65535
    v_add_u32 v60, 93696, v1
    v_and_b32 v61, 0xfc, v9
    ds_write_b128 v60, v[56:59]
    ds_write_b128 v60, v[56:59] offset:10240
    ds_write_b128 v60, v[56:59] offset:15360
    ds_write_b32 v61, v24
    s_waitcnt vmcnt(4)
    v_mul_u32_u24 v28, 42800, v4
    v_mul_u32_u24 v29, 42800, v5
    v_mul_u32_u24 v30, 42800, v6
    v_mul_u32_u24 v31, 42800, v7
    v_mul_u32_u24 v32, 42800, v8
    v_lshrrev_b32 v44, 21, v28
    v_lshrrev_b32 v45, 21, v29
    v_lshrrev_b32 v46, 21, v30
    v_lshrrev_b32 v47, 21, v31
    v_lshrrev_b32 v48, 21, v32
    v_lshlrev_b32 v28, 2, v44
    ds_add_rtn_u32 v36, v28, v3 offset:17408
    v_lshlrev_b32 v29, 2, v45
    ds_add_rtn_u32 v37, v29, v3 offset:17408
    v_lshlrev_b32 v30, 2, v46
    ds_add_rtn_u32 v38, v30, v3 offset:17408
    v_lshlrev_b32 v31, 2, v47
    ds_add_rtn_u32 v39, v31, v3 offset:17408
    v_lshlrev_b32 v32, 2, v48
    ds_add_rtn_u32 v40, v32, v3 offset:17408
    v_lshl_add_u32 v4, v4, 2, 4
    v_lshl_add_u32 v5, v5, 2, 4
    v_lshl_add_u32 v6, v6, 2, 4
    v_lshl_add_u32 v7, v7, 2, 4
    v_lshl_add_u32 v8, v8, 2, 4
    v_mad_i32_i24 v4, v44, s45, v4
    v_mad_i32_i24 v5, v45, s45, v5
    v_mad_i32_i24 v6, v46, s45, v6
    v_mad_i32_i24 v7, v47, s45, v7
    v_mad_i32_i24 v8, v48, s45, v8
    s_waitcnt lgkmcnt(4)
    v_min_u32 v44, s47, v36
    v_bfe_u32 v52, v44, 13, 2
    v_lshrrev_b32 v44, 13, v44
    v_mad_u32_u24 v44, v28, 13, v44
    v_lshl_add_u32 v44, v44, 2, s48
    v_mad_i32_i24 v52, v52, -3, v44
    ds_write_b8 v52, v4 offset:12
    s_waitcnt lgkmcnt(4)
    v_min_u32 v45, s47, v37
    v_bfe_u32 v53, v45, 13, 2
    v_lshrrev_b32 v45, 13, v45
    v_mad_u32_u24 v45, v29, 13, v45
    v_lshl_add_u32 v45, v45, 2, s48
    v_mad_i32_i24 v53, v53, -3, v45
    ds_write_b8 v53, v5 offset:12
    s_waitcnt lgkmcnt(4)
    v_min_u32 v46, s47, v38
    v_bfe_u32 v54, v46, 13, 2
    v_lshrrev_b32 v46, 13, v46
    v_mad_u32_u24 v46, v30, 13, v46
    v_lshl_add_u32 v46, v46, 2, s48
    v_mad_i32_i24 v54, v54, -3, v46
    ds_write_b8 v54, v6 offset:12
    s_waitcnt lgkmcnt(4)
    v_min_u32 v47, s47, v39
    v_bfe_u32 v55, v47, 13, 2
    v_lshrrev_b32 v47, 13, v47
    v_mad_u32_u24 v47, v31, 13, v47
    v_lshl_add_u32 v47, v47, 2, s48
    v_mad_i32_i24 v55, v55, -3, v47
    ds_write_b8 v55, v7 offset:12
    s_waitcnt lgkmcnt(4)
    v_min_u32 v48, s47, v40
    v_bfe_u32 v56, v48, 13, 2
    v_lshrrev_b32 v48, 13, v48
    v_mad_u32_u24 v48, v32, 13, v48
    v_lshl_add_u32 v48, v48, 2, s48
    v_mad_i32_i24 v56, v56, -3, v48
    ds_write_b8 v56, v8 offset:12
    v_max3_u32 v2, v36, v37, v38
    v_max3_u32 v2, v2, v39, v40
    v_cmp_le_u32 s[50:51], s47, v2
    s_add_u32 s6, s8, 5505024
    s_addc_u32 s7, s9, 0
    s_load_dwordx2 s[38:39], s[6:7], 0
    s_waitcnt vmcnt(2)
    v_lshl_or_b32 v12, v20, 16, v12
    ds_write_b32 v44, v12
    v_and_or_b32 v13, v20, s46, v13
    ds_write_b32 v45, v13
    v_lshl_or_b32 v14, v21, 16, v14
    ds_write_b32 v46, v14
    v_and_or_b32 v15, v21, s46, v15
    ds_write_b32 v47, v15
    s_waitcnt vmcnt(0)
    v_lshl_or_b32 v16, v22, 16, v16
    ds_write_b32 v48, v16
    s_waitcnt lgkmcnt(0)
    s_barrier
    ds_read_b128 v[64:67], v62
    ds_read_b128 v[68:71], v62 offset:19968
    ds_read_b128 v[72:75], v62 offset:39936
    s_mul_i32 s38, s38, 1664525
    s_add_u32 s38, s38, 1013904223
    s_add_u32 s39, s39, 1
    s_and_b32 s6, s39, 63
    s_mul_i32 s6, s6, 0x1041
    s_and_b32 s6, s6, 0x030303
    s_lshl_b32 s7, s39, 18
    s_and_b32 s7, s7, 0xff000000
    s_or_b32 s24, s6, s7
    s_and_b32 s25, s39, 0xc0c0c0c0
    s_or_b32 s25, s25, 0x40
    s_mov_b32 s26, s38
    s_mov_b32 s27, s39
    s_cmp_eq_u32 s4, 15
    s_cbranch_scc1 L_copied
    s_cmp_ge_u32 s4, 12
    s_waitcnt lgkmcnt(2)
    v_and_or_b32 v67, v67, v63, s24
    buffer_store_dwordx4 v[64:67], v1, s[16:19], s40 offen sc1
    s_waitcnt lgkmcnt(1)
    v_and_or_b32 v71, v71, v63, s24
    buffer_store_dwordx4 v[68:71], v1, s[16:19], s41 offen sc1
    s_cbranch_scc1 L_copied
    s_waitcnt lgkmcnt(0)
    v_and_or_b32 v75, v75, v63, s24
    buffer_store_dwordx4 v[72:75], v1, s[16:19], s42 offen sc1
L_copied:
    s_cmp_eq_u64 s[50:51], 0
    s_cbranch_scc0 L_overflow
L_common:
    s_waitcnt  lgkmcnt(0)
    s_barrier
    s_call_b64 s[70:71], L_consts
L_common2:
    ds_read_b64 v[88:89], v114 offset:21504
    s_or_b32 s9, s9, 8388608
    s_mov_b32 s10, 12500
    v_lshlrev_b32 v1, 4, v0
L_round:
    v_lshrrev_b32 v2, 2, v0
    v_mul_u32_u24 v14, 512, v2
    s_lshr_b32 s7, s3, 2
    s_lshl_b32 s7, s7, 3
    ds_read_b128 v[4:7], v1 offset:1024
    v_mul_u32_u24 v2, 75776, v2
    v_and_b32 v3, 3, v0
    v_mul_u32_u24 v13, 3, v3
    s_mul_i32 s6, s3, 96
    v_add3_u32 v35, v2, v111, s6
    s_lshl_b32 s6, s3, 7
    s_add_u32 s6, s6, 24480
    v_add3_u32 v32, v2, v111, s6
    s_mov_b32 vcc_lo, 0xcccccccc
    s_mov_b32 vcc_hi, 0xcccccccc
    v_cndmask_b32 v49, v35, v32, vcc
    v_cndmask_b32 v48, 12, 18, vcc
    v_mov_b32 v34, 0x7ffffff0
    v_mov_b32 v3, 4
    s_mov_b32 s69, 93184
    s_movk_i32 s64, 0xfc
    s_and_b32 s65, s3, 3
    s_lshl_b32 s65, s65, 3
    s_mov_b32 s68, 0xc0c0c0c0
    v_mov_b32 v40, 0
    v_mov_b32 v41, 0
    v_mov_b32 v42, 0
    v_mov_b32 v43, 0
    ds_write_b128 v1, v[40:43] offset:40448
    ds_write_b128 v1, v[40:43] offset:56832
    s_waitcnt lgkmcnt(2)
    v_exp_f32 v8, v4
    v_exp_f32 v9, v5
    v_exp_f32 v10, v6
    v_exp_f32 v11, v7
    v_add_f32 v8, 1.0, v8
    v_add_f32 v9, 1.0, v9
    v_add_f32 v10, 1.0, v10
    v_add_f32 v11, 1.0, v11
    v_rcp_f32 v8, v8
    v_rcp_f32 v9, v9
    v_rcp_f32 v10, v10
    v_rcp_f32 v11, v11
    v_mul_f32 v104, v4, v8
    v_mul_f32 v105, v5, v9
    v_mul_f32 v106, v6, v10
    v_mul_f32 v107, v7, v11
    s_waitcnt vmcnt(0)
    s_barrier
L_poll:
    buffer_load_dwordx2 v[50:51], v14, s[12:15], s7 offen sc1
    s_waitcnt vmcnt(0)
L_poll1:
    s_add_u32 s61, s61, 1
    v_and_b32 v15, s68, v51
    v_cmp_ne_u32 vcc, s26, v50
    v_cmp_ne_u32 s[70:71], s25, v15
    s_or_b64 exec, vcc, s[70:71]
    s_cbranch_execz L_poll_done
    s_sleep 2
    s_cmp_lt_u32 s61, 400000
    s_cbranch_scc1 L_poll
    v_mov_b32 v51, 0
L_poll_done:
    s_mov_b64 exec, -1
    v_bfe_u32 v15, v51, s65, 6
    s_cmp_lg_u32 s54, 0
    s_cbranch_scc1 L_later
    v_sub_u32 v37, v15, v13
    v_cmp_lt_u32 s[28:29], 0, v15
    v_cmp_lt_u32 s[30:31], v48, v15
    v_cmp_lt_u32 s[32:33], 24, v15
L_loads:
    v_cndmask_b32 v44, v34, v35, s[28:29]
    v_cndmask_b32 v45, v34, v49, s[30:31]
    v_cndmask_b32 v36, v34, v32, s[32:33]
L_reload:
    buffer_load_dwordx4 v[16:19], v44, s[16:19], 0 offen sc1
    buffer_load_dwordx4 v[20:23], v45, s[16:19], 0 offen offset:64 sc1
    buffer_load_dwordx4 v[24:27], v36, s[16:19], 0 offen offset:128 sc1
    v_cmp_lt_i32 s[36:37], 0, v37
    v_cmp_lt_i32 s[42:43], 12, v37
    v_cmp_lt_i32 s[48:49], 24, v37
    v_cmp_lt_i32 vcc, 36, v37
    v_cmp_lt_i32 s[38:39], 1, v37
    v_cmp_lt_i32 s[40:41], 2, v37
    v_cmp_lt_i32 s[44:45], 13, v37
    v_cmp_lt_i32 s[46:47], 14, v37
    v_cmp_lt_i32 s[50:51], 25, v37
    v_cmp_lt_i32 s[52:53], 26, v37
    s_mov_b64 exec, vcc
    ds_write_b32 v113, v3 offset:240
    s_mov_b64 exec, -1
    s_cmp_lt_u32 s4, 8
    s_cselect_b32 s73, 32, 0
    v_add_u32 v58, s73, v117
    v_lshl_add_u32 v54, v118, 1, v58
    v_lshl_or_b32 v54, v54, 16, v118
    v_add_u32 v55, 0x1000000, v54
    s_mov_b32 exec_lo, 0x10001
    s_mov_b32 exec_hi, 0x10001
    v_or_b32 v54, 0x8000, v54
    s_mov_b64 exec, -1
    v_and_b32 v46, 63, v0
    s_lshr_b32 s6, s2, 3
    s_mul_i32 s6, s6, 25
    s_sub_u32 s7, 784, s6
    s_min_u32 s7, s7, 8
    s_bfm_b64 s[66:67], s7, 0
    s_mul_i32 s7, s4, 784
    s_add_u32 s6, s6, s7
    v_add_u32 v12, s6, v46
    v_lshlrev_b32 v47, 2, v46
    v_lshrrev_b32 v57, 6, v118
    v_add_u32 v56, 4, v57
    v_add_u32 v53, 256, v58
    v_and_b32 v59, 12, v57
    v_bfe_u32 v61, v0, 2, 1
    v_bfe_u32 v33, v0, 3, 3
    v_and_b32 v33, 4, v33
    v_lshl_add_u32 v61, v61, 3, v33
    s_lshl_b32 s6, s4, 11
    v_lshl_add_u32 v95, v61, 7, s6
    v_add_u32 v95, v95, v127
    v_lshrrev_b32 v57, 2, v117
    s_mov_b32 vcc_lo, 0xfffffffe
    s_mov_b32 vcc_hi, 0x1
    v_cndmask_b32 v96, 0, 2, vcc
    s_mov_b32 s6, 0xff030303
    s_waitcnt vmcnt(0)
    v_and_b32 v28, s6, v19
    v_and_b32 v29, s6, v23
    v_and_b32 v30, s6, v27
    v_cmp_ne_u32 vcc, s24, v28
    v_cmp_ne_u32 s[34:35], s24, v29
    v_cmp_ne_u32 s[70:71], s24, v30
    s_and_b64 vcc, vcc, s[28:29]
    s_and_b64 s[34:35], s[34:35], s[30:31]
    s_and_b64 s[70:71], s[70:71], s[32:33]
    s_or_b64 vcc, vcc, s[34:35]
    s_or_b64 vcc, vcc, s[70:71]
    s_cbranch_scc1 L_notyet
L_arrived:
    s_movk_i32 s6, 0x1fc
    s_mov_b64 exec, s[36:37]
    v_and_b32_sdwa v28, v19, s64 dst_sel:DWORD dst_unused:UNUSED_PAD src0_sel:BYTE_0 src1_sel:DWORD
    ds_add_rtn_u32 v37, v28, v3
    v_lshl_add_u32 v64, v28, 7, s69
    s_mov_b64 exec, s[38:39]
    v_and_b32_sdwa v29, v19, s64 dst_sel:DWORD dst_unused:UNUSED_PAD src0_sel:BYTE_1 src1_sel:DWORD
    ds_add_rtn_u32 v38, v29, v3
    v_lshl_add_u32 v65, v29, 7, s69
    s_mov_b64 exec, s[40:41]
    v_and_b32_sdwa v30, v19, s64 dst_sel:DWORD dst_unused:UNUSED_PAD src0_sel:BYTE_2 src1_sel:DWORD
    ds_add_rtn_u32 v39, v30, v3
    v_lshl_add_u32 v66, v30, 7, s69
    s_mov_b64 exec, s[42:43]
    v_and_b32_sdwa v31, v23, s64 dst_sel:DWORD dst_unused:UNUSED_PAD src0_sel:BYTE_0 src1_sel:DWORD
    ds_add_rtn_u32 v40, v31, v3
    v_lshl_add_u32 v67, v31, 7, s69
    s_mov_b64 exec, s[44:45]
    v_and_b32_sdwa v32, v23, s64 dst_sel:DWORD dst_unused:UNUSED_PAD src0_sel:BYTE_1 src1_sel:DWORD
    ds_add_rtn_u32 v41, v32, v3
    v_lshl_add_u32 v68, v32, 7, s69
    s_mov_b64 exec, s[46:47]
    v_and_b32_sdwa v33, v23, s64 dst_sel:DWORD dst_unused:UNUSED_PAD src0_sel:BYTE_2 src1_sel:DWORD
    ds_add_rtn_u32 v42, v33, v3
    v_lshl_add_u32 v69, v33, 7, s69
    s_waitcnt lgkmcnt(0)
    s_mov_b64 exec, s[36:37]
    v_and_or_b32 v64, v37, s6, v64
    ds_write_b32 v64, v16
    s_mov_b64 exec, s[38:39]
    v_and_or_b32 v65, v38, s6, v65
    ds_write_b32 v65, v17
    s_mov_b64 exec, s[40:41]
    v_and_or_b32 v66, v39, s6, v66
    ds_write_b32 v66, v18
    s_mov_b64 exec, s[42:43]
    v_and_or_b32 v67, v40, s6, v67
    ds_write_b32 v67, v20
    s_mov_b64 exec, s[44:45]
    v_and_or_b32 v68, v41, s6, v68
    ds_write_b32 v68, v21
    s_mov_b64 exec, s[46:47]
    v_and_or_b32 v69, v42, s6, v69
    ds_write_b32 v69, v22
    s_cmp_eq_u64 s[48:49], 0
    s_cbranch_scc1 L_skipA
    s_mov_b64 exec, s[48:49]
    v_and_b32_sdwa v34, v27, s64 dst_sel:DWORD dst_unused:UNUSED_PAD src0_sel:BYTE_0 src1_sel:DWORD
    ds_add_rtn_u32 v43, v34, v3
    v_lshl_add_u32 v70, v34, 7, s69
    s_mov_b64 exec, s[50:51]
    v_and_b32_sdwa v35, v27, s64 dst_sel:DWORD dst_unused:UNUSED_PAD src0_sel:BYTE_1 src1_sel:DWORD
    ds_add_rtn_u32 v44, v35, v3
    v_lshl_add_u32 v71, v35, 7, s69
    s_mov_b64 exec, s[52:53]
    v_and_b32_sdwa v36, v27, s64 dst_sel:DWORD dst_unused:UNUSED_PAD src0_sel:BYTE_2 src1_sel:DWORD
    ds_add_rtn_u32 v45, v36, v3
    v_lshl_add_u32 v72, v36, 7, s69
    s_waitcnt lgkmcnt(0)
    s_mov_b64 exec, s[48:49]
    v_and_or_b32 v70, v43, s6, v70
    ds_write_b32 v70, v24
    s_mov_b64 exec, s[50:51]
    v_and_or_b32 v71, v44, s6, v71
    ds_write_b32 v71, v25
    s_mov_b64 exec, s[52:53]
    v_and_or_b32 v72, v45, s6, v72
    ds_write_b32 v72, v26
L_skipA:
    s_mov_b64 exec, s[66:67]
    buffer_load_dword v63, v12, s[8:11], 0 idxen
    s_mov_b64 exec, -1
    s_movk_i32 s6, 512
    s_cmp_lg_u32 s4, 14
    s_cbranch_scc1 L_not14
    s_setprio 3
L_not14:
    s_cmp_eq_u32 s73, 0
    s_waitcnt lgkmcnt(0)
    s_barrier
    ds_read_b32 v48, v47
    ds_read_b32 v52, v56
    s_cbranch_scc1 L_noearly
    ds_read_u16 v110, v95
    ds_read_u16 v92, v95 offset:16
    ds_read_u16 v112, v95 offset:2
    ds_read_u16 v94, v95 offset:18
    s_waitcnt lgkmcnt(3)
    buffer_load_dwordx4 v[64:67], v[110:111], s[8:11], 0 idxen offen
    buffer_load_dwordx4 v[68:71], v[110:111], s[8:11], 0 idxen offen offset:64
    s_waitcnt lgkmcnt(2)
    v_mov_b32 v110, v92
    buffer_load_dwordx4 v[72:75], v[110:111], s[8:11], 0 idxen offen
    buffer_load_dwordx4 v[76:79], v[110:111], s[8:11], 0 idxen offen offset:64
L_noearly:
    s_waitcnt lgkmcnt(0)
    v_cmp_lt_u32 vcc, s6, v48
    v_add_u32 v49, 12, v48
    v_lshrrev_b32 v49, 4, v49
    s_cbranch_vccnz L_noadj
    v_sub_u32 v49, v49, v96 clamp
L_adj:
    v_readlane_b32 s60, v48, 60
    v_max_u32 v15, s73, v52
    v_add_u32_dpp v50, v49, v49 row_shr:1 row_mask:0xf bank_mask:0xf bound_ctrl:0
    v_add_u32 v15, 12, v15
    v_and_b32 v15, -16, v15
    v_add_u32_dpp v50, v50, v50 row_shr:2 row_mask:0xf bank_mask:0xf bound_ctrl:0
    v_sub_u32 v15, v15, v52
    v_cvt_f32_u32 v15, v15
    v_add_u32_dpp v50, v50, v50 row_shr:4 row_mask:0xf bank_mask:0xf bound_ctrl:0
    v_mul_f32 v15, 0xbe800000, v15
    v_add_u32 v116, 32768, v1
    v_add_u32_dpp v50, v50, v50 row_shr:8 row_mask:0xf bank_mask:0xf bound_ctrl:0
    v_mul_f32 v104, v15, v104
    v_mul_f32 v105, v15, v105
    v_add_u32_dpp v50, v50, v50 row_bcast:15 row_mask:0xa bank_mask:0xf
    v_mul_f32 v106, v15, v106
    v_mul_f32 v107, v15, v107
    v_add_u32_dpp v50, v50, v50 row_bcast:31 row_mask:0xc bank_mask:0xf
    v_sub_u32 v49, v50, v49
    v_readlane_b32 s56, v50, 50
    ds_bpermute_b32 v51, v56, v49
    s_cbranch_vccnz L_compact
    s_cmp_ge_u32 s4, 13
    s_cbranch_scc1 L_special
    s_cmp_eq_u32 s73, 0
    s_cbranch_scc1 L_table
    ds_read_b128 v[32:35], v1 offset:1024
    ds_read_b128 v[36:39], v1 offset:1024
    ds_read_b128 v[40:43], v1 offset:1024
    ds_read_b128 v[44:47], v1 offset:1024
    s_add_u32 s6, s56, 3
    s_lshr_b32 s6, s6, 2
    s_lshr_b32 s58, s6, 4
    s_and_b32 s59, s6, 15
    s_cmp_lt_u32 s4, s59
    s_addc_u32 s57, s58, 0
    s_min_u32 s6, s4, s59
    s_mul_i32 s7, s4, s58
    s_add_u32 s6, s6, s7
    s_lshl_b32 s6, s6, 4
    v_mul_u32_u24 v120, s57, v59
    v_mul_u32_u24 v121, s57, v61
    v_add_u32 v120, s6, v120
    v_add_u32 v121, s6, v121
    v_add_u32 v96, v120, v57
    s_mov_b64 s[62:63], 0
    s_mov_b64 s[66:67], 0
    s_movk_i32 s64, 0x7fff
    s_mov_b32 s34, 0x10001
    s_mov_b32 s35, 0x10001
    s_cmp_gt_u32 s57, 16
    s_cselect_b64 s[28:29], -1, s[34:35]
    s_cselect_b64 s[70:71], -1, 0
    s_cselect_b64 s[32:33], -4, 0x400
    s_add_u32 s57, s57, 2
    s_bitset1_b64 s[32:33], s57
    s_cmp_lt_u32 s4, 8
    s_subb_u32 s68, s57, 4
    s_add_u32 s69, s68, 2
    s_bitset1_b64 s[70:71], s68
    s_bitset1_b64 s[70:71], s69
    v_lshlrev_b64 v[90:91], v111, v[112:113]
    v_mov_b32 v112, v94
L_table:
    v_cmp_gt_u32 vcc, v52, v58
    v_cmp_gt_u32 s[6:7], v52, v53
    s_waitcnt lgkmcnt(0)
    v_lshl_add_u32 v51, v51, 2, v57
    s_mov_b64 exec, vcc
    ds_write_b32 v51, v54 offset:17408
    s_mov_b64 exec, s[6:7]
    ds_write_b32 v51, v55 offset:17472
    s_branch L_tables_done
L_special:
    s_cmp_eq_u32 s4, 14
    s_cbranch_scc0 L_special2
    s_add_u32 s6, s56, 3
    s_lshr_b32 s6, s6, 2
    s_lshr_b32 s58, s6, 4
    s_and_b32 s59, s6, 15
    s_add_u32 s6, s58, 1
    s_lshl_b32 s65, s59, 2
    s_mul_i32 s7, s65, s6
    v_cvt_f32_u32 v64, s6
    v_cvt_f32_u32 v53, s58
    v_rcp_f32 v64, v64
    v_rcp_f32 v53, v53
    v_subrev_u32 v54, s7, v49
    v_cvt_f32_u32 v55, v49
    v_cvt_f32_u32 v54, v54
    v_add_f32 v55, 0.5, v55
    v_add_f32 v54, 0.5, v54
    v_mul_f32 v55, v55, v64
    v_mul_f32 v54, v54, v53
    v_cvt_u32_f32 v55, v55
    v_cvt_u32_f32 v54, v54
    v_cmp_gt_u32 vcc, s7, v49
    v_min_u32 v54, 64, v54
    v_add_u32 v54, s65, v54
    v_cndmask_b32 v54, v54, v55, vcc
    v_min_u32 v54, 64, v54
    v_add_lshl_u32 v54, v54, v46, 8
    ds_write_b32 v47, v54 offset:512
    s_branch L_tables_done
L_special2:
    s_cmp_eq_u32 s4, 15
    s_cbranch_scc0 L_tables_done
    v_add_lshl_u32 v53, v46, s56, 2
    v_mov_b32 v54, 2581639424
    s_mov_b64 exec, 0xffff
    ds_write_b32 v53, v54 offset:17408
L_tables_done:
    s_cmp_eq_u32 s2, 0
    s_cbranch_scc1 L_seed
L_seeded:
    s_mov_b64 exec, -1
    s_cmp_eq_u32 s73, 0
    s_cbranch_scc1 L_normal
    s_cmp_eq_u32 s54, 0
    s_cbranch_scc1 L_pc0e
    ds_read_b128 v[16:19], v116 offset:40448
    s_waitcnt lgkmcnt(0)
    v_pk_add_f32 v[104:105], v[104:105], v[16:17]
    v_pk_add_f32 v[106:107], v[106:107], v[18:19]
L_pc0e:
    s_mov_b32 s30, 0
    s_setprio 3
    s_waitcnt lgkmcnt(0)
    s_barrier
    ds_read_u16 v93, v121 offset:17410
    ds_read_u16 v119, v121 offset:17414
    ds_read_i16 v96, v96 offset:17408
    ds_read_u16 v97, v120 offset:17408
    ds_read_u16 v60, v121 offset:17418
L_join:
    ds_read_b32 v62, v56 offset:512
    ds_read_b32 v61, v56 offset:516
    s_waitcnt vmcnt(2)
    v_mfma_f32_32x32x16_bf16 v[0:15], v[64:67], v[80:83], v[32:47]
    s_waitcnt lgkmcnt(4)
    v_add_u32 v93, v93, v127
    v_add_u32 v119, v119, v127
    ds_read_u16 v110, v93
    ds_read_u16 v92, v119
    ds_read_u16 v94, v93 offset:2
    v_mfma_f32_32x32x16_bf16 v[0:15], v[68:71], v[84:87], v[0:15]
    v_cmp_gt_i32 vcc, 0, v96
    v_mfma_f32_32x32x8_bf16 v[0:15], v[90:91], v[88:89], v[0:15]
    s_or_b64 s[28:29], s[28:29], vcc
    s_or_b32 s6, s28, s29
    s_lshr_b32 s7, s6, 16
    s_or_b32 s6, s6, s7
    s_and_b32 s6, s6, 0xffff
    s_or_b32 s70, s70, s6
    s_lshl_b32 s6, s6, 2
    s_or_b32 s32, s32, s6
    v_lshlrev_b64 v[90:91], v111, v[112:113]
    s_cmp_eq_u32 s30, 0
    s_waitcnt lgkmcnt(2)
    buffer_load_dwordx4 v[64:67], v[110:111], s[8:11], 0 idxen offen
    buffer_load_dwordx4 v[68:71], v[110:111], s[8:11], 0 idxen offen offset:64
    s_cbranch_scc1 L_join_nc
    s_ashr_i64 s[66:67], s[28:29], 1
    s_and_b64 s[66:67], s[66:67], s[34:35]
    s_cbranch_scc0 L_join_nc
    s_mul_i32 s66, s66, 0xffff
    s_mul_i32 s67, s67, 0xffff
    s_mov_b64 exec, s[66:67]
    v_and_or_b32 v63, v114, s64, v117
    ds_read_b128 v[32:35], v63 offset:1024
    ds_read_b128 v[36:39], v63 offset:1024
    ds_read_b128 v[40:43], v63 offset:1024
    ds_read_b128 v[44:47], v63 offset:1024
    s_mov_b64 exec, -1
L_join_nc:
    s_waitcnt vmcnt(2) lgkmcnt(0)
    v_mov_b32 v114, v97
    v_mov_b32 v110, v92
    v_mov_b32 v112, v94
    s_cmp_eq_u32 s55, 0
    s_cbranch_scc0 L_safe0
.p2align 6
L_fast0:
    v_mfma_f32_32x32x16_bf16 v[16:31], v[72:75], v[80:83], v[32:47]
    v_exp_f32 v48, v0
    v_exp_f32 v49, v1
    v_exp_f32 v50, v2
    v_mfma_f32_32x32x16_bf16 v[16:31], v[76:79], v[84:87], v[16:31]
    v_exp_f32 v51, v3
    v_exp_f32 v52, v4
    v_exp_f32 v53, v5
    v_mfma_f32_32x32x8_bf16 v[16:31], v[90:91], v[88:89], v[16:31]
    v_exp_f32 v54, v6
    v_exp_f32 v55, v7
    v_lshlrev_b64 v[90:91], v111, v[112:113]
    v_lshl_add_u64 v[120:121], v[120:121], 0, s[0:1]
    v_exp_f32 v56, v8
    v_exp_f32 v57, v9
    v_exp_f32 v58, v10
    v_exp_f32 v59, v11
    buffer_load_dwordx4 v[72:75], v[110:111], s[8:11], 0 idxen offen
    buffer_load_dwordx4 v[76:79], v[110:111], s[8:11], 0 idxen offen offset:64
    s_cbranch_scc1 L_fast0_first
    s_bitcmp1_b64 s[70:71], s30
    v_pk_fma_f32 v[100:101], v[92:93], v[48:49], v[92:93]
    v_pk_fma_f32 v[102:103], v[94:95], v[50:51], v[94:95]
    v_pk_fma_f32 v[92:93], v[0:1], v[96:97], v[100:101]
    v_pk_fma_f32 v[94:95], v[2:3], v[98:99], v[102:103]
    v_pk_fma_f32 v[96:97], v[96:97], v[48:49], v[96:97]
    v_pk_fma_f32 v[98:99], v[98:99], v[50:51], v[98:99]
    v_pk_fma_f32 v[100:101], v[92:93], v[52:53], v[92:93]
    v_pk_fma_f32 v[102:103], v[94:95], v[54:55], v[94:95]
    s_cbranch_scc1 L_fast0_c
L_fast0_nc:
    s_add_u32 s30, s30, 1
    v_exp_f32 v48, v12
    v_exp_f32 v49, v13
    ds_read_u16 v112, v119 offset:2
    v_add_u32_e64 v119, v60, v127
    v_exp_f32 v50, v14
    v_exp_f32 v51, v15
    ds_read_u16 v110, v119
    v_pk_fma_f32 v[92:93], v[4:5], v[96:97], v[100:101]
    v_pk_fma_f32 v[94:95], v[6:7], v[98:99], v[102:103]
    ds_read_u16 v114, v120 offset:17404
    v_pk_fma_f32 v[96:97], v[96:97], v[52:53], v[96:97]
    v_pk_fma_f32 v[98:99], v[98:99], v[54:55], v[98:99]
    ds_read_u16 v60, v121 offset:17414
    v_pk_fma_f32 v[100:101], v[92:93], v[56:57], v[92:93]
    v_pk_fma_f32 v[102:103], v[94:95], v[58:59], v[94:95]
    v_pk_fma_f32 v[92:93], v[8:9], v[96:97], v[100:101]
    v_pk_fma_f32 v[94:95], v[10:11], v[98:99], v[102:103]
    v_pk_fma_f32 v[96:97], v[96:97], v[56:57], v[96:97]
    v_pk_fma_f32 v[98:99], v[98:99], v[58:59], v[98:99]
    v_pk_fma_f32 v[100:101], v[92:93], v[48:49], v[92:93]
    v_pk_fma_f32 v[102:103], v[94:95], v[50:51], v[94:95]
    v_pk_fma_f32 v[92:93], v[12:13], v[96:97], v[100:101]
    v_pk_fma_f32 v[94:95], v[14:15], v[98:99], v[102:103]
    v_pk_fma_f32 v[96:97], v[96:97], v[48:49], v[96:97]
    v_pk_fma_f32 v[98:99], v[98:99], v[50:51], v[98:99]
    s_bitcmp1_b64 s[32:33], s30
    s_waitcnt vmcnt(2) lgkmcnt(0)
    s_cbranch_scc1 L_fast0_fin
L_fast1:
    v_mfma_f32_32x32x16_bf16 v[0:15], v[64:67], v[80:83], v[32:47]
    v_exp_f32_e64 v48, v16
    v_exp_f32 v49, v17
    v_exp_f32 v50, v18
    v_mfma_f32_32x32x16_bf16 v[0:15], v[68:71], v[84:87], v[0:15]
    v_exp_f32 v51, v19
    v_exp_f32 v52, v20
    v_exp_f32 v53, v21
    v_mfma_f32_32x32x8_bf16 v[0:15], v[90:91], v[88:89], v[0:15]
    v_exp_f32 v54, v22
    v_exp_f32 v55, v23
    v_lshlrev_b64 v[90:91], v111, v[112:113]
    v_exp_f32 v56, v24
    v_exp_f32 v57, v25
    v_exp_f32 v58, v26
    v_exp_f32 v59, v27
    buffer_load_dwordx4 v[64:67], v[110:111], s[8:11], 0 idxen offen
    buffer_load_dwordx4 v[68:71], v[110:111], s[8:11], 0 idxen offen offset:64
    s_cbranch_scc1 L_fast1_first
    s_bitcmp1_b64 s[70:71], s30
    v_pk_fma_f32 v[100:101], v[92:93], v[48:49], v[92:93]
    v_pk_fma_f32 v[102:103], v[94:95], v[50:51], v[94:95]
    v_pk_fma_f32 v[92:93], v[16:17], v[96:97], v[100:101]
    v_pk_fma_f32 v[94:95], v[18:19], v[98:99], v[102:103]
    v_pk_fma_f32 v[96:97], v[96:97], v[48:49], v[96:97]
    v_pk_fma_f32 v[98:99], v[98:99], v[50:51], v[98:99]
    v_pk_fma_f32 v[100:101], v[92:93], v[52:53], v[92:93]
    v_pk_fma_f32 v[102:103], v[94:95], v[54:55], v[94:95]
    s_cbranch_scc1 L_fast1_c
L_fast1_nc:
    s_add_u32 s30, s30, 1
    v_exp_f32 v48, v28
    v_exp_f32 v49, v29
    ds_read_u16 v112, v119 offset:2
    v_add_u32_e64 v119, v60, v127
    v_exp_f32 v50, v30
    v_exp_f32 v51, v31
    ds_read_u16 v110, v119
    v_pk_fma_f32 v[92:93], v[20:21], v[96:97], v[100:101]
    v_pk_fma_f32 v[94:95], v[22:23], v[98:99], v[102:103]
    ds_read_u16 v114, v120 offset:17408
    v_pk_fma_f32 v[96:97], v[96:97], v[52:53], v[96:97]
    v_pk_fma_f32 v[98:99], v[98:99], v[54:55], v[98:99]
    ds_read_u16 v60, v121 offset:17418
    v_pk_fma_f32 v[100:101], v[92:93], v[56:57], v[92:93]
    v_pk_fma_f32 v[102:103], v[94:95], v[58:59], v[94:95]
    v_pk_fma_f32 v[92:93], v[24:25], v[96:97], v[100:101]
    v_pk_fma_f32 v[94:95], v[26:27], v[98:99], v[102:103]
    v_pk_fma_f32 v[96:97], v[96:97], v[56:57], v[96:97]
    v_pk_fma_f32 v[98:99], v[98:99], v[58:59], v[98:99]
    v_pk_fma_f32 v[100:101], v[92:93], v[48:49], v[92:93]
    v_pk_fma_f32 v[102:103], v[94:95], v[50:51], v[94:95]
    v_pk_fma_f32 v[92:93], v[28:29], v[96:97], v[100:101]
    v_pk_fma_f32 v[94:95], v[30:31], v[98:99], v[102:103]
    v_pk_fma_f32 v[96:97], v[96:97], v[48:49], v[96:97]
    v_pk_fma_f32 v[98:99], v[98:99], v[50:51], v[98:99]
    s_bitcmp1_b64 s[32:33], s30
    s_waitcnt vmcnt(2) lgkmcnt(0)
    s_cbranch_scc0 L_fast0
    v_rcp_f32_e64 v100, v96
    v_rcp_f32 v101, v97
    v_rcp_f32 v102, v98
    v_rcp_f32 v103, v99
    v_pk_add_f32 v[108:109], v[108:109], v[96:97]
    v_pk_add_f32 v[108:109], v[108:109], v[98:99]
    v_pk_fma_f32 v[104:105], v[92:93], v[100:101], v[104:105]
    v_pk_fma_f32 v[106:107], v[94:95], v[102:103], v[106:107]
    s_cmp_lg_u32 s30, s57
    s_cbranch_scc1 L_fast0
L_loop_exit:
    ds_write_b128 v116, v[104:107] offset:40448
L_loop_done:
    s_setprio 0
    s_mov_b32 s6, 32768
    v_add3_u32 v1, v118, v117, s6
    ds_read_b128 v[4:7], v1 offset:40448
    ds_read_b128 v[48:51], v122
    ds_read_b128 v[52:55], v122 offset:64
    ds_read_b64_tr_b16 v[32:33], v126 offset:0
    ds_read_b64_tr_b16 v[34:35], v126 offset:576
    ds_read_b64_tr_b16 v[36:37], v126 offset:4608
    ds_read_b64_tr_b16 v[38:39], v126 offset:5184
    ds_read_b64_tr_b16 v[40:41], v126 offset:9216
    ds_read_b64_tr_b16 v[42:43], v126 offset:9792
    ds_read_b64_tr_b16 v[44:45], v126 offset:13824
    ds_read_b64_tr_b16 v[46:47], v126 offset:14400
    v_add_f32 v100, v108, v109
    v_sub_u32 v61, v61, v62
    v_add_u32 v62, v117, v62
    s_movk_i32 s46, 0x207
    s_cmp_ge_u32 s4, 12
    s_cselect_b64 s[50:51], 15, -1
    s_cselect_b64 s[36:37], 0xffff, -1
    s_cmp_gt_u32 s4, 12
    s_waitcnt lgkmcnt(11)
    s_barrier
    s_cbranch_scc1 L_fold_done
    s_mov_b64 exec, s[36:37]
    ds_read_b128 v[16:19], v62 offset:40192
    ds_read_b128 v[20:23], v62 offset:40448
    ds_read_b128 v[24:27], v62 offset:40704
    s_movk_i32 s6, 256
    s_movk_i32 s7, 512
    v_cmp_lt_u32 vcc, 768, v61
    v_cmp_lt_u32 s[38:39], s6, v61
    v_cmp_lt_u32 s[40:41], s7, v61
    s_mov_b32 s44, 0xbf317218
    s_mov_b32 s45, 0xbf317218
    s_waitcnt lgkmcnt(2)
    v_pk_add_f32 v[4:5], v[4:5], v[16:17]
    v_pk_add_f32 v[6:7], v[6:7], v[18:19]
    s_mov_b64 exec, s[38:39]
    s_waitcnt lgkmcnt(1)
    v_pk_add_f32 v[4:5], v[4:5], v[20:21]
    v_pk_add_f32 v[6:7], v[6:7], v[22:23]
    s_mov_b64 exec, s[40:41]
    s_waitcnt lgkmcnt(0)
    v_pk_add_f32 v[4:5], v[4:5], v[24:25]
    v_pk_add_f32 v[6:7], v[6:7], v[26:27]
    s_cbranch_vccnz L_fold_more
L_fold2:
    s_mov_b64 exec, s[36:37]
    v_pk_mul_f32 v[8:9], v[4:5], s[44:45]
    v_pk_mul_f32 v[10:11], v[6:7], s[44:45]
    v_cvt_pk_bf16_f32 v12, v8, v9
    v_cvt_pk_bf16_f32 v13, v10, v11
    ds_write_b64 v124, v[12:13]
    v_pk_add_f32 v[8:9], v[8:9], v[10:11]
    v_add_f32 v100, v8, v100
    v_add_f32 v100, v9, v100
L_fold_done:
    s_mov_b64 exec, -1
    v_cmp_class_f32 vcc, v100, s46
    s_cbranch_vccnz L_setflag
L_flagged:
    s_cmp_eq_u32 s60, 0
    s_cbranch_scc0 L_more
    s_waitcnt lgkmcnt(0)
    s_barrier
    ds_read_b128 v[16:19], v123
    ds_read_b128 v[20:23], v123 offset:1088
    ds_read_b32 v2, v113 offset:768
    v_mfma_f32_16x16x32_bf16 v[56:59], v[32:35], v[48:51], 0
    v_mfma_f32_16x16x32_bf16 v[56:59], v[36:39], v[52:55], v[56:59]
    s_and_b32 s6, s4, 3
    s_lshl_b32 s6, s6, 5
    s_add_u32 s6, s6, s5
    s_lshr_b32 s7, s4, 2
    s_lshl_b32 s7, s7, 11
    s_add_u32 s48, s6, s7
    s_waitcnt lgkmcnt(2)
    v_mfma_f32_16x16x32_bf16 v[56:59], v[40:43], v[16:19], v[56:59]
    s_waitcnt lgkmcnt(1)
    v_mfma_f32_16x16x32_bf16 v[56:59], v[44:47], v[20:23], v[56:59]
    v_lshrrev_b32 v3, 5, v125
    v_lshl_add_u32 v3, v111, 2, v3
    s_nop 5
    v_mul_f32 v4, s72, v56
    v_mul_f32 v5, s72, v57
    v_mul_f32 v6, s72, v58
    v_mul_f32 v7, s72, v59
    v_exp_f32 v4, v4
    v_exp_f32 v5, v5
    v_exp_f32 v6, v6
    v_exp_f32 v7, v7
    s_nop 0
    v_pk_add_f32 v[4:5], v[4:5], 1.0 op_sel_hi:[1,0]
    v_pk_add_f32 v[6:7], v[6:7], 1.0 op_sel_hi:[1,0]
    v_rcp_f32 v4, v4
    v_rcp_f32 v5, v5
    v_rcp_f32 v6, v6
    v_rcp_f32 v7, v7
    s_waitcnt lgkmcnt(0)
    v_pk_mul_f32 v[4:5], v[4:5], v[56:57]
    v_pk_mul_f32 v[6:7], v[6:7], v[58:59]
    v_cvt_pk_bf16_f32 v4, v4, v5
    v_cvt_pk_bf16_f32 v5, v6, v7
    ds_bpermute_b32 v4, v3, v4
    ds_bpermute_b32 v5, v3, v5
    v_readfirstlane_b32 s6, v2
    s_mov_b64 exec, s[50:51]
    s_waitcnt lgkmcnt(0)
    buffer_store_dwordx2 v[4:5], v125, s[20:23], s48 offen
    s_cmp_gt_u32 s6, s55
    s_cbranch_scc1 L_restart
L_k2_end:
    s_endpgm
L_fold_more:
    s_movk_i32 s7, 512
L_fold:
    s_add_u32 s7, s7, 256
    v_cmp_lt_u32 vcc, s7, v61
    s_and_b64 exec, exec, vcc
    s_cbranch_execz L_fold2
    ds_read_b128 v[16:19], v62 offset:40960
    v_add_u32 v62, 256, v62
    s_waitcnt lgkmcnt(0)
    v_pk_add_f32 v[4:5], v[4:5], v[16:17]
    v_pk_add_f32 v[6:7], v[6:7], v[18:19]
    s_branch L_fold
L_normal:
    s_mov_b32 s30, 2
    s_waitcnt lgkmcnt(0)
    s_barrier
    s_setprio 3
    s_cmp_ge_u32 s4, 13
    s_cbranch_scc1 L_pc1n
    s_cmp_eq_u32 s54, 0
    s_cbranch_scc1 L_pc0n
    ds_read_b128 v[16:19], v116 offset:40448
    s_waitcnt lgkmcnt(0)
    v_pk_add_f32 v[104:105], v[104:105], v[16:17]
    v_pk_add_f32 v[106:107], v[106:107], v[18:19]
L_pc0n:
    ds_write_b128 v116, v[104:107] offset:40448
L_pc1n:
    s_add_u32 s6, s56, 3
    s_lshr_b32 s6, s6, 2
    s_lshr_b32 s58, s6, 4
    s_and_b32 s59, s6, 15
    s_cmp_lt_u32 s4, s59
    s_addc_u32 s57, s58, 0
    s_min_u32 s6, s4, s59
    s_mul_i32 s7, s4, s58
    s_add_u32 s6, s6, s7
    s_lshl_b32 s6, s6, 4
    v_mul_u32_u24 v120, s57, v59
    v_mul_u32_u24 v121, s57, v61
    v_add_u32 v120, s6, v120
    v_add_u32 v121, s6, v121
    v_add_u32 v96, v120, v57
    s_mov_b64 s[62:63], 0
    s_mov_b64 s[66:67], 0
    s_movk_i32 s64, 0x7fff
    s_mov_b32 s34, 0x10001
    s_mov_b32 s35, 0x10001
    s_cmp_gt_u32 s57, 16
    s_cselect_b64 s[28:29], -1, s[34:35]
    s_cselect_b64 s[70:71], -1, 0
    s_cselect_b64 s[32:33], -4, 0x400
    s_add_u32 s57, s57, 2
    s_bitset1_b64 s[32:33], s57
    s_cmp_lt_u32 s4, 8
    s_subb_u32 s68, s57, 4
    s_add_u32 s69, s68, 2
    s_bitset1_b64 s[70:71], s68
    s_bitset1_b64 s[70:71], s69
    s_cmp_eq_u32 s57, 2
    s_cbranch_scc1 L_skip_loop
    ds_read_u16 v95, v121 offset:17410
    ds_read_u16 v98, v121 offset:17414
    ds_read_u16 v115, v120 offset:17408
    ds_read_u16 v93, v121 offset:17418
    ds_read_u16 v119, v121 offset:17422
    ds_read_u16 v60, v121 offset:17426
    ds_read_u16 v114, v120 offset:17412
    ds_read_u16 v97, v120 offset:17416
    ds_read_i16 v96, v96 offset:17408
    v_add_u32 v120, 8, v120
    v_add_u32 v121, 8, v121
    s_waitcnt lgkmcnt(6)
    v_add_u32 v95, v95, v127
    v_add_u32 v98, v98, v127
    ds_read_u16 v110, v95
    ds_read_u16 v92, v98
    ds_read_u16 v112, v95 offset:2
    ds_read_u16 v94, v98 offset:2
    v_and_or_b32 v115, v115, s64, v117
    ds_read_b128 v[32:35], v115 offset:1024
    ds_read_b128 v[36:39], v115 offset:1024
    ds_read_b128 v[40:43], v115 offset:1024
    ds_read_b128 v[44:47], v115 offset:1024
    v_add_u32 v116, v115, v118
    s_waitcnt lgkmcnt(7)
    buffer_load_dwordx4 v[64:67], v[110:111], s[8:11], 0 idxen offen
    buffer_load_dwordx4 v[68:71], v[110:111], s[8:11], 0 idxen offen offset:64
    s_waitcnt lgkmcnt(6)
    v_mov_b32 v110, v92
    buffer_load_dwordx4 v[72:75], v[110:111], s[8:11], 0 idxen offen
    buffer_load_dwordx4 v[76:79], v[110:111], s[8:11], 0 idxen offen offset:64
    s_waitcnt lgkmcnt(0)
    v_lshlrev_b64 v[90:91], v111, v[112:113]
    v_mov_b32 v112, v94
    v_mov_b32 v104, 0
    v_mov_b32 v105, 0
    v_mov_b32 v106, 0
    v_mov_b32 v107, 0
    s_branch L_join
.p2align 3
L_fast0_first:
    v_pk_add_f32 v[96:97], v[48:49], 1.0 op_sel_hi:[1,0]
    v_pk_add_f32 v[98:99], v[50:51], 1.0 op_sel_hi:[1,0]
    v_pk_fma_f32 v[100:101], v[0:1], v[52:53], v[0:1]
    v_pk_fma_f32 v[102:103], v[2:3], v[54:55], v[2:3]
    s_mov_b64 exec, s[62:63]
    s_cbranch_execz L_fast0_nf0
    ds_write_b128 v116, v[104:107] offset:40448
    v_add_u32_e64 v116, v115, v118
    ds_read_b128 v[104:107], v116 offset:40448
L_fast0_nf0:
    s_mov_b64 exec, -1
    s_mov_b64 s[62:63], 0
    s_bitcmp1_b64 s[70:71], s30
    s_cbranch_scc0 L_fast0_nc
L_fast0_c:
    s_cmp_lt_i32 s30, s68
    s_cbranch_scc1 L_fast0_p
    s_setprio 2
    s_cmp_lt_i32 s30, s69
    s_cbranch_scc1 L_fast0_p
    s_setprio 1
L_fast0_p:
    s_ashr_i64 s[62:63], s[28:29], s30
    s_and_b64 s[62:63], s[62:63], s[34:35]
    s_cbranch_scc0 L_fast0_nc
    s_mul_i32 s62, s62, 0xffff
    s_mul_i32 s63, s63, 0xffff
    s_mov_b64 exec, s[62:63]
    v_and_or_b32 v115, v114, s64, v117
    ds_read_b128 v[32:35], v115 offset:1024
    ds_read_b128 v[36:39], v115 offset:1024
    ds_read_b128 v[40:43], v115 offset:1024
    ds_read_b128 v[44:47], v115 offset:1024
    s_mov_b64 exec, -1
    s_branch L_fast0_nc
.p2align 3
L_fast0_fin:
    v_rcp_f32 v100, v96
    v_rcp_f32 v101, v97
    v_rcp_f32 v102, v98
    v_rcp_f32 v103, v99
    v_pk_add_f32 v[108:109], v[108:109], v[96:97]
    v_pk_add_f32 v[108:109], v[108:109], v[98:99]
    v_pk_fma_f32 v[104:105], v[92:93], v[100:101], v[104:105]
    v_pk_fma_f32 v[106:107], v[94:95], v[102:103], v[106:107]
    s_cmp_lg_u32 s30, s57
    s_cbranch_scc1 L_fast1
    s_branch L_loop_exit
.p2align 3
L_fast1_first:
    v_pk_add_f32 v[96:97], v[48:49], 1.0 op_sel_hi:[1,0]
    v_pk_add_f32 v[98:99], v[50:51], 1.0 op_sel_hi:[1,0]
    v_pk_fma_f32 v[100:101], v[16:17], v[52:53], v[16:17]
    v_pk_fma_f32 v[102:103], v[18:19], v[54:55], v[18:19]
    s_mov_b64 exec, s[66:67]
    s_cbranch_execz L_fast1_nf0
    ds_write_b128 v116, v[104:107] offset:40448
    v_add_u32_e64 v116, v63, v118
    ds_read_b128 v[104:107], v116 offset:40448
L_fast1_nf0:
    s_mov_b64 exec, -1
    s_mov_b64 s[66:67], 0
    s_bitcmp1_b64 s[70:71], s30
    s_cbranch_scc0 L_fast1_nc
L_fast1_c:
    s_cmp_lt_i32 s30, s68
    s_cbranch_scc1 L_fast1_p
    s_setprio 2
    s_cmp_lt_i32 s30, s69
    s_cbranch_scc1 L_fast1_p
    s_setprio 1
L_fast1_p:
    s_ashr_i64 s[66:67], s[28:29], s30
    s_and_b64 s[66:67], s[66:67], s[34:35]
    s_cbranch_scc0 L_fast1_nc
    s_mul_i32 s66, s66, 0xffff
    s_mul_i32 s67, s67, 0xffff
    s_mov_b64 exec, s[66:67]
    v_and_or_b32 v63, v114, s64, v117
    ds_read_b128 v[32:35], v63 offset:1024
    ds_read_b128 v[36:39], v63 offset:1024
    ds_read_b128 v[40:43], v63 offset:1024
    ds_read_b128 v[44:47], v63 offset:1024
    s_mov_b64 exec, -1
    s_branch L_fast1_nc
L_consts:
    s_add_u32 s16, s8, 6291456
    s_addc_u32 s17, s9, 0
    s_add_u32 s12, s8, 5373952
    s_addc_u32 s13, s9, 0
    s_mov_b32 s11, 0x20000
    s_mov_b32 s14, 131080
    s_mov_b32 s15, 0x20000
    s_mov_b32 s18, 18944000
    s_mov_b32 s19, 0x20000
    s_mov_b32 s20, s36
    s_mov_b32 s21, s37
    s_mov_b32 s22, 1600000
    s_mov_b32 s23, 0x20000
    s_mov_b32 s54, 0
    s_mov_b32 s55, 0
    s_mov_b32 s61, 0
    s_mov_b32 s0, 8
    s_mov_b32 s1, 8
    s_mov_b32 s72, 0xbfb8aa3b
    v_lshlrev_b32 v48, 4, v0
    v_and_b32 v117, 0xf0, v48
    v_and_b32 v118, 0x3f00, v48
    v_and_b32 v111, 0x30, v48
    v_bfe_u32 v114, v48, 1, 9
    v_mov_b32 v108, 0
    v_mov_b32 v109, 0
    v_mov_b32 v113, 0
    ds_write_b32 v113, v113 offset:768
    v_lshrrev_b32 v49, 1, v0
    v_and_b32 v127, 12, v49
    v_add_u32 v127, 93696, v127
    v_and_b32 v50, 16, v48
    v_mov_b32 v51, 0x3f80
    v_lshlrev_b32 v50, v50, v51
    s_mov_b32 vcc_lo, 0x3
    s_mov_b32 vcc_hi, 0x30000
    v_cndmask_b32 v80, v113, v50, vcc
    s_mov_b32 vcc_lo, 0xc
    s_mov_b32 vcc_hi, 0xc0000
    v_cndmask_b32 v81, v113, v50, vcc
    s_mov_b32 vcc_lo, 0x30
    s_mov_b32 vcc_hi, 0x300000
    v_cndmask_b32 v82, v113, v50, vcc
    s_mov_b32 vcc_lo, 0xc0
    s_mov_b32 vcc_hi, 0xc00000
    v_cndmask_b32 v83, v113, v50, vcc
    s_mov_b32 vcc_lo, 0x300
    s_mov_b32 vcc_hi, 0x3000000
    v_cndmask_b32 v84, v113, v50, vcc
    s_mov_b32 vcc_lo, 0xc00
    s_mov_b32 vcc_hi, 0xc000000
    v_cndmask_b32 v85, v113, v50, vcc
    s_mov_b32 vcc_lo, 0x3000
    s_mov_b32 vcc_hi, 0x30000000
    v_cndmask_b32 v86, v113, v50, vcc
    s_mov_b32 vcc_lo, 0xc000
    s_mov_b32 vcc_hi, 0xc0000000
    v_cndmask_b32 v87, v113, v50, vcc
    s_and_b32 s64, s4, 3
    s_lshr_b32 s65, s4, 2
    v_bfe_u32 v52, v0, 4, 2
    v_bfe_u32 v126, v0, 2, 2
    v_lshl_add_u32 v126, v52, 3, v126
    v_mul_u32_u24 v126, 144, v126
    v_lshrrev_b32 v53, 1, v111
    s_lshl_b32 s6, s64, 5
    s_add_u32 s6, s6, 142336
    v_add3_u32 v126, v126, v53, s6
    v_and_b32 v53, 0x30, v0
    v_mad_u32_u24 v122, v117, 9, v53
    s_mul_i32 s6, s65, 2304
    s_add_u32 s6, s6, 133120
    v_add_u32 v122, s6, v122
    s_mul_i32 s7, s65, 2176
    s_add_u32 s7, s7, 27136
    v_mad_u32_u24 v123, v53, 17, v117
    v_add_u32 v123, s7, v123
    v_lshrrev_b32 v54, 5, v117
    v_mul_u32_u24 v124, 272, v54
    v_and_b32 v54, 8, v114
    s_lshl_b32 s6, s64, 6
    s_add_u32 s7, s7, s6
    v_add3_u32 v124, v124, v54, s7
    v_add_u32 v124, v124, v53
    v_bfe_u32 v54, v0, 2, 4
    v_lshrrev_b32 v125, 1, v111
    v_lshl_add_u32 v125, v54, 7, v125
    v_mov_b32 v54, 65535
    ds_write_b32 v127, v54 offset:39392
    s_setpc_b64 s[70:71]
L_idle:
    s_waitcnt lgkmcnt(0)
    s_add_u32 s6, s8, 5505024
    s_addc_u32 s7, s9, 0
    s_load_dwordx2 s[38:39], s[6:7], 0
    s_barrier
    v_subrev_u32 v9, 384, v0
    v_lshlrev_b32 v1, 4, v9
    v_mov_b32 v56, 65535
    v_mov_b32 v57, 65535
    v_mov_b32 v58, 65535
    v_mov_b32 v59, 65535
    v_add_u32 v60, 93696, v1
    v_and_b32 v61, 0xfc, v9
    ds_write_b128 v60, v[56:59]
    ds_write_b128 v60, v[56:59] offset:10240
    ds_write_b128 v60, v[56:59] offset:15360
    ds_write_b32 v61, v24
    s_waitcnt lgkmcnt(0)
    s_mul_i32 s38, s38, 1664525
    s_add_u32 s38, s38, 1013904223
    s_add_u32 s39, s39, 1
    s_and_b32 s6, s39, 63
    s_mul_i32 s6, s6, 0x1041
    s_and_b32 s6, s6, 0x030303
    s_lshl_b32 s7, s39, 18
    s_and_b32 s7, s7, 0xff000000
    s_or_b32 s24, s6, s7
    s_and_b32 s25, s39, 0xc0c0c0c0
    s_or_b32 s25, s25, 0x40
    s_mov_b32 s26, s38
    s_mov_b32 s27, s39
    s_barrier
    s_branch L_common
L_aux:
    s_and_b32 s3, s2, 7
    s_lshl_b32 s3, s3, 5
    s_lshr_b32 s64, s2, 3
    s_add_u32 s3, s3, s64
    s_sub_u32 s3, 255, s3
    s_mul_i32 s5, s3, 6272
    s_lshr_b32 s4, s4, 6
    v_lshlrev_b32 v1, 4, v0
    v_lshrrev_b32 v2, 3, v0
    v_mul_u32_u24 v2, 144, v2
    v_and_b32 v3, 0x70, v1
    v_add_u32 v2, v2, v3
    v_add_u32 v2, 142336, v2
    v_and_b32 v60, 0x3f0, v1
    v_add_u32 v4, 4096, v1
    v_add_u32 v5, 12288, v1
    v_bfe_u32 v6, v1, 1, 7
    v_add_u32 v6, 16384, v6
    s_waitcnt lgkmcnt(0)
    s_add_u32 s6, s8, 5505024
    s_addc_u32 s7, s9, 0
    s_load_dwordx2 s[38:39], s[6:7], 0
    s_call_b64 s[70:71], L_consts
    s_mul_i32 s40, s3, 512
    s_cmp_eq_u32 s4, 1
    s_cbranch_scc0 L_aux1
    buffer_store_dwordx2 v[108:109], v114, s[12:15], s40 offen sc1
L_aux1:
    global_load_dwordx2 v[10:11], v6, s[32:33]
    global_load_dwordx4 v[16:19], v4, s[34:35] offset:-4096
    global_load_dwordx4 v[20:23], v4, s[34:35] offset:-2048
    global_load_dwordx4 v[24:27], v4, s[34:35] offset:0
    global_load_dwordx4 v[28:31], v4, s[34:35] offset:2048
    global_load_dwordx4 v[32:35], v5, s[34:35] offset:-4096
    global_load_dwordx4 v[36:39], v5, s[34:35] offset:-2048
    global_load_dwordx4 v[40:43], v5, s[34:35] offset:0
    global_load_dwordx4 v[44:47], v5, s[34:35] offset:2048
    s_waitcnt lgkmcnt(0)
    s_mul_i32 s38, s38, 1664525
    s_add_u32 s38, s38, 1013904223
    s_add_u32 s39, s39, 1
    s_and_b32 s6, s39, 63
    s_mul_i32 s6, s6, 0x1041
    s_and_b32 s6, s6, 0x030303
    s_lshl_b32 s7, s39, 18
    s_and_b32 s7, s7, 0xff000000
    s_or_b32 s24, s6, s7
    s_and_b32 s25, s39, 0xc0c0c0c0
    s_or_b32 s25, s25, 0x40
    s_mov_b32 s26, s38
    s_mov_b32 s27, s39
    s_barrier
    s_waitcnt vmcnt(0)
    ds_write_b128 v2, v[16:19] offset:0
    ds_write_b128 v2, v[20:23] offset:2304
    ds_write_b128 v2, v[24:27] offset:4608
    ds_write_b128 v2, v[28:31] offset:6912
    ds_write_b128 v2, v[32:35] offset:9216
    ds_write_b128 v2, v[36:39] offset:11520
    ds_write_b128 v2, v[40:43] offset:13824
    ds_write_b128 v2, v[44:47] offset:16128
    s_cmp_eq_u32 s4, 1
    s_cbranch_scc1 L_row
    s_mov_b32 vcc_lo, 0x0000ffff
    s_mov_b32 vcc_hi, 0xffff0000
    v_cndmask_b32 v10, 0, v10, vcc
    v_cndmask_b32 v11, 0, v11, vcc
    v_lshlrev_b32 v12, 16, v10
    v_and_b32 v13, 0xffff0000, v10
    v_lshlrev_b32 v14, 16, v11
    v_and_b32 v15, 0xffff0000, v11
    v_mul_f32 v12, s72, v12
    v_mul_f32 v13, s72, v13
    v_mul_f32 v14, s72, v14
    v_mul_f32 v15, s72, v15
    v_cvt_pk_bf16_f32 v10, v12, v13
    v_cvt_pk_bf16_f32 v11, v14, v15
    ds_write_b64 v114, v[10:11] offset:21504
    s_waitcnt lgkmcnt(0)
    s_barrier
    s_branch L_common2
L_row:
    ds_read_b128 v[52:55], v60 offset:17408
    s_waitcnt lgkmcnt(0)
    v_lshl_add_u32 v40, v52, 1, v52
    v_lshl_add_u32 v41, v53, 1, v53
    v_lshl_add_u32 v42, v54, 1, v54
    v_lshl_add_u32 v43, v55, 1, v55
    v_lshrrev_b32 v40, 15, v40
    v_lshrrev_b32 v41, 15, v41
    v_lshrrev_b32 v42, 15, v42
    v_lshrrev_b32 v43, 15, v43
    v_max3_u32 v6, v40, v41, v42
    v_max_u32 v6, v6, v43
    v_cmp_lt_u32 vcc, 36, v6
    s_cbranch_vccz L_row1
    v_add_u32 v44, 21846, v52
    v_add_u32 v45, 21846, v53
    v_add_u32 v46, 21846, v54
    v_add_u32 v47, 21846, v55
    v_lshrrev_b32 v44, 15, v44
    v_lshrrev_b32 v45, 15, v45
    v_lshrrev_b32 v46, 15, v46
    v_lshrrev_b32 v47, 15, v47
    v_sub_u32 v44, v44, 12 clamp
    v_sub_u32 v45, v45, 12 clamp
    v_sub_u32 v46, v46, 12 clamp
    v_sub_u32 v47, v47, 12 clamp
    v_add_u32 v48, v44, v45
    v_add_u32 v49, v48, v46
    v_add_u32 v50, v49, v47
    s_nop 1
    v_add_u32_dpp v61, v50, v50 row_shr:1 row_mask:0xf bank_mask:0xf bound_ctrl:0
    s_nop 1
    v_add_u32_dpp v61, v61, v61 row_shr:2 row_mask:0xf bank_mask:0xf bound_ctrl:0
    s_nop 1
    v_add_u32_dpp v61, v61, v61 row_shr:4 row_mask:0xf bank_mask:0xf bound_ctrl:0
    s_nop 1
    v_add_u32_dpp v61, v61, v61 row_shr:8 row_mask:0xf bank_mask:0xf bound_ctrl:0
    s_nop 1
    v_add_u32_dpp v61, v61, v61 row_bcast:15 row_mask:0xa bank_mask:0xf
    s_nop 1
    v_add_u32_dpp v61, v61, v61 row_bcast:31 row_mask:0xc bank_mask:0xf
    v_sub_u32 v56, v61, v50
    v_add_u32 v57, v56, v44
    v_add_u32 v58, v56, v48
    v_add_u32 v59, v56, v49
    v_lshl_or_b32 v56, v40, 16, v56
    v_lshl_or_b32 v57, v41, 16, v57
    v_lshl_or_b32 v58, v42, 16, v58
    v_lshl_or_b32 v59, v43, 16, v59
    s_mul_i32 s40, s3, 75776
    s_add_u32 s40, s40, 57344
    buffer_store_dwordx4 v[56:59], v60, s[16:19], s40 offen sc1
L_row1:
    v_min_u32 v40, 37, v40
    v_min_u32 v41, 37, v41
    v_min_u32 v42, 37, v42
    v_min_u32 v43, 37, v43
    v_lshl_or_b32 v40, v41, 8, v40
    v_lshl_or_b32 v42, v43, 8, v42
    v_lshl_or_b32 v53, v42, 16, v40
    v_mov_b32 v52, s38
    v_or_b32 v53, s25, v53
    s_mul_i32 s6, s3, 512
    s_waitcnt vmcnt(0) lgkmcnt(0)
    s_barrier
    buffer_store_dwordx2 v[52:53], v114, s[12:15], s6 offen sc1
    s_branch L_common2
L_overflow:
    v_and_b32 v60, 0x3f0, v1
    ds_read_b128 v[52:55], v60 offset:17408
    s_waitcnt lgkmcnt(0)
    v_add_u32 v44, 21846, v52
    v_add_u32 v45, 21846, v53
    v_add_u32 v46, 21846, v54
    v_add_u32 v47, 21846, v55
    v_lshrrev_b32 v44, 15, v44
    v_lshrrev_b32 v45, 15, v45
    v_lshrrev_b32 v46, 15, v46
    v_lshrrev_b32 v47, 15, v47
    v_sub_u32 v44, v44, 12 clamp
    v_sub_u32 v45, v45, 12 clamp
    v_sub_u32 v46, v46, 12 clamp
    v_sub_u32 v47, v47, 12 clamp
    v_add_u32 v48, v44, v45
    v_add_u32 v49, v48, v46
    v_add_u32 v50, v49, v47
    s_nop 1
    v_add_u32_dpp v61, v50, v50 row_shr:1 row_mask:0xf bank_mask:0xf bound_ctrl:0
    s_nop 1
    v_add_u32_dpp v61, v61, v61 row_shr:2 row_mask:0xf bank_mask:0xf bound_ctrl:0
    s_nop 1
    v_add_u32_dpp v61, v61, v61 row_shr:4 row_mask:0xf bank_mask:0xf bound_ctrl:0
    s_nop 1
    v_add_u32_dpp v61, v61, v61 row_shr:8 row_mask:0xf bank_mask:0xf bound_ctrl:0
    s_nop 1
    v_add_u32_dpp v61, v61, v61 row_bcast:15 row_mask:0xa bank_mask:0xf
    s_nop 1
    v_add_u32_dpp v61, v61, v61 row_bcast:31 row_mask:0xc bank_mask:0xf
    v_sub_u32 v56, v61, v50
    v_add_u32 v57, v56, v44
    v_add_u32 v58, v56, v48
    v_add_u32 v59, v56, v49
    ds_write_b128 v60, v[56:59] offset:18432
    s_add_u32 s44, s40, 58176
    v_cmp_le_u32 vcc, s47, v36
    s_and_b64 exec, exec, vcc
    s_cbranch_execz L_o0
    ds_read_b32 v44, v28 offset:18432
    v_lshrrev_b32 v45, 13, v36
    v_and_b32 v46, 3, v45
    s_waitcnt lgkmcnt(0)
    v_lshl_add_u32 v45, v44, 2, v45
    v_lshlrev_b32 v45, 2, v45
    v_mad_i32_i24 v46, v46, -3, v45
    buffer_store_dword v12, v45, s[16:19], s44 offen sc1
    buffer_store_byte v4, v46, s[16:19], s44 offen offset:12 sc1
L_o0:
    s_mov_b64 exec, -1
    v_cmp_le_u32 vcc, s47, v37
    s_and_b64 exec, exec, vcc
    s_cbranch_execz L_o1
    ds_read_b32 v44, v29 offset:18432
    v_lshrrev_b32 v45, 13, v37
    v_and_b32 v46, 3, v45
    s_waitcnt lgkmcnt(0)
    v_lshl_add_u32 v45, v44, 2, v45
    v_lshlrev_b32 v45, 2, v45
    v_mad_i32_i24 v46, v46, -3, v45
    buffer_store_dword v13, v45, s[16:19], s44 offen sc1
    buffer_store_byte v5, v46, s[16:19], s44 offen offset:12 sc1
L_o1:
    s_mov_b64 exec, -1
    v_cmp_le_u32 vcc, s47, v38
    s_and_b64 exec, exec, vcc
    s_cbranch_execz L_o2
    ds_read_b32 v44, v30 offset:18432
    v_lshrrev_b32 v45, 13, v38
    v_and_b32 v46, 3, v45
    s_waitcnt lgkmcnt(0)
    v_lshl_add_u32 v45, v44, 2, v45
    v_lshlrev_b32 v45, 2, v45
    v_mad_i32_i24 v46, v46, -3, v45
    buffer_store_dword v14, v45, s[16:19], s44 offen sc1
    buffer_store_byte v6, v46, s[16:19], s44 offen offset:12 sc1
L_o2:
    s_mov_b64 exec, -1
    v_cmp_le_u32 vcc, s47, v39
    s_and_b64 exec, exec, vcc
    s_cbranch_execz L_o3
    ds_read_b32 v44, v31 offset:18432
    v_lshrrev_b32 v45, 13, v39
    v_and_b32 v46, 3, v45
    s_waitcnt lgkmcnt(0)
    v_lshl_add_u32 v45, v44, 2, v45
    v_lshlrev_b32 v45, 2, v45
    v_mad_i32_i24 v46, v46, -3, v45
    buffer_store_dword v15, v45, s[16:19], s44 offen sc1
    buffer_store_byte v7, v46, s[16:19], s44 offen offset:12 sc1
L_o3:
    s_mov_b64 exec, -1
    v_cmp_le_u32 vcc, s47, v40
    s_and_b64 exec, exec, vcc
    s_cbranch_execz L_o4
    ds_read_b32 v44, v32 offset:18432
    v_lshrrev_b32 v45, 13, v40
    v_and_b32 v46, 3, v45
    s_waitcnt lgkmcnt(0)
    v_lshl_add_u32 v45, v44, 2, v45
    v_lshlrev_b32 v45, 2, v45
    v_mad_i32_i24 v46, v46, -3, v45
    buffer_store_dword v16, v45, s[16:19], s44 offen sc1
    buffer_store_byte v8, v46, s[16:19], s44 offen offset:12 sc1
L_o4:
    s_mov_b64 exec, -1
    s_waitcnt vmcnt(0)
    s_branch L_common
.p2align 6
L_safe0:
    v_mfma_f32_32x32x16_bf16 v[16:31], v[72:75], v[80:83], v[32:47]
    v_exp_f32 v48, v0
    v_exp_f32 v49, v1
    v_exp_f32 v50, v2
    v_mfma_f32_32x32x16_bf16 v[16:31], v[76:79], v[84:87], v[16:31]
    v_exp_f32 v51, v3
    v_exp_f32 v52, v4
    v_exp_f32 v53, v5
    v_mfma_f32_32x32x8_bf16 v[16:31], v[90:91], v[88:89], v[16:31]
    v_exp_f32 v54, v6
    v_exp_f32 v55, v7
    v_lshlrev_b64 v[90:91], v111, v[112:113]
    v_lshl_add_u64 v[120:121], v[120:121], 0, s[0:1]
    v_exp_f32 v56, v8
    v_exp_f32 v57, v9
    v_exp_f32 v58, v10
    v_exp_f32 v59, v11
    buffer_load_dwordx4 v[72:75], v[110:111], s[8:11], 0 idxen offen
    buffer_load_dwordx4 v[76:79], v[110:111], s[8:11], 0 idxen offen offset:64
    s_mov_b64 exec, s[62:63]
    s_cbranch_execz L_safe0_nf0
    ds_write_b128 v116, v[104:107] offset:40448
    v_add_u32_e64 v116, v115, v118
    ds_read_b128 v[104:107], v116 offset:40448
L_safe0_nf0:
    s_mov_b64 exec, -1
L_safe0_nf:
    s_ashr_i64 s[62:63], s[28:29], s30
    s_and_b64 s[62:63], s[62:63], s[34:35]
    s_cbranch_scc0 L_safe0_nc
    s_mul_i32 s62, s62, 0xffff
    s_mul_i32 s63, s63, 0xffff
    s_mov_b64 exec, s[62:63]
    v_and_or_b32 v115, v114, s64, v117
    ds_read_b128 v[32:35], v115 offset:1024
    ds_read_b128 v[36:39], v115 offset:1024
    ds_read_b128 v[40:43], v115 offset:1024
    ds_read_b128 v[44:47], v115 offset:1024
    s_mov_b64 exec, -1
L_safe0_nc:
    s_waitcnt lgkmcnt(0)
    ds_read_u16 v112, v119 offset:2
    v_add_u32_e64 v119, v60, v127
    ds_read_u16 v110, v119
    ds_read_u16 v114, v120 offset:17404
    ds_read_u16 v60, v121 offset:17414
    v_pk_add_f32 v[48:49], v[48:49], 1.0 op_sel_hi:[1,0]
    v_pk_add_f32 v[50:51], v[50:51], 1.0 op_sel_hi:[1,0]
    v_rcp_f32 v48, v48
    v_rcp_f32 v49, v49
    v_rcp_f32 v50, v50
    v_rcp_f32 v51, v51
    s_nop 0
    v_pk_fma_f32 v[104:105], v[0:1], v[48:49], v[104:105]
    v_pk_fma_f32 v[106:107], v[2:3], v[50:51], v[106:107]
    v_exp_f32 v48, v12
    v_exp_f32 v49, v13
    v_exp_f32 v50, v14
    v_exp_f32 v51, v15
    v_pk_add_f32 v[52:53], v[52:53], 1.0 op_sel_hi:[1,0]
    v_pk_add_f32 v[54:55], v[54:55], 1.0 op_sel_hi:[1,0]
    v_rcp_f32 v52, v52
    v_rcp_f32 v53, v53
    v_rcp_f32 v54, v54
    v_rcp_f32 v55, v55
    s_nop 0
    v_pk_fma_f32 v[104:105], v[4:5], v[52:53], v[104:105]
    v_pk_fma_f32 v[106:107], v[6:7], v[54:55], v[106:107]
    v_pk_add_f32 v[56:57], v[56:57], 1.0 op_sel_hi:[1,0]
    v_pk_add_f32 v[58:59], v[58:59], 1.0 op_sel_hi:[1,0]
    v_rcp_f32 v56, v56
    v_rcp_f32 v57, v57
    v_rcp_f32 v58, v58
    v_rcp_f32 v59, v59
    s_nop 0
    v_pk_fma_f32 v[104:105], v[8:9], v[56:57], v[104:105]
    v_pk_fma_f32 v[106:107], v[10:11], v[58:59], v[106:107]
    v_pk_add_f32 v[48:49], v[48:49], 1.0 op_sel_hi:[1,0]
    v_pk_add_f32 v[50:51], v[50:51], 1.0 op_sel_hi:[1,0]
    v_rcp_f32 v48, v48
    v_rcp_f32 v49, v49
    v_rcp_f32 v50, v50
    v_rcp_f32 v51, v51
    s_nop 0
    v_pk_fma_f32 v[104:105], v[12:13], v[48:49], v[104:105]
    v_pk_fma_f32 v[106:107], v[14:15], v[50:51], v[106:107]
    s_add_u32 s30, s30, 1
    s_cmp_lg_u32 s30, s57
    s_waitcnt vmcnt(2) lgkmcnt(0)
    s_cbranch_scc0 L_loop_exit
L_safe1:
    v_mfma_f32_32x32x16_bf16 v[0:15], v[64:67], v[80:83], v[32:47]
    v_exp_f32 v48, v16
    v_exp_f32 v49, v17
    v_exp_f32 v50, v18
    v_mfma_f32_32x32x16_bf16 v[0:15], v[68:71], v[84:87], v[0:15]
    v_exp_f32 v51, v19
    v_exp_f32 v52, v20
    v_exp_f32 v53, v21
    v_mfma_f32_32x32x8_bf16 v[0:15], v[90:91], v[88:89], v[0:15]
    v_exp_f32 v54, v22
    v_exp_f32 v55, v23
    v_lshlrev_b64 v[90:91], v111, v[112:113]
    v_exp_f32 v56, v24
    v_exp_f32 v57, v25
    v_exp_f32 v58, v26
    v_exp_f32 v59, v27
    buffer_load_dwordx4 v[64:67], v[110:111], s[8:11], 0 idxen offen
    buffer_load_dwordx4 v[68:71], v[110:111], s[8:11], 0 idxen offen offset:64
    s_mov_b64 exec, s[66:67]
    s_cbranch_execz L_safe1_nf0
    ds_write_b128 v116, v[104:107] offset:40448
    v_add_u32_e64 v116, v63, v118
    ds_read_b128 v[104:107], v116 offset:40448
L_safe1_nf0:
    s_mov_b64 exec, -1
L_safe1_nf:
    s_ashr_i64 s[66:67], s[28:29], s30
    s_and_b64 s[66:67], s[66:67], s[34:35]
    s_cbranch_scc0 L_safe1_nc
    s_mul_i32 s66, s66, 0xffff
    s_mul_i32 s67, s67, 0xffff
    s_mov_b64 exec, s[66:67]
    v_and_or_b32 v63, v114, s64, v117
    ds_read_b128 v[32:35], v63 offset:1024
    ds_read_b128 v[36:39], v63 offset:1024
    ds_read_b128 v[40:43], v63 offset:1024
    ds_read_b128 v[44:47], v63 offset:1024
    s_mov_b64 exec, -1
L_safe1_nc:
    s_waitcnt lgkmcnt(0)
    ds_read_u16 v112, v119 offset:2
    v_add_u32_e64 v119, v60, v127
    ds_read_u16 v110, v119
    ds_read_u16 v114, v120 offset:17408
    ds_read_u16 v60, v121 offset:17418
    v_pk_add_f32 v[48:49], v[48:49], 1.0 op_sel_hi:[1,0]
    v_pk_add_f32 v[50:51], v[50:51], 1.0 op_sel_hi:[1,0]
    v_rcp_f32 v48, v48
    v_rcp_f32 v49, v49
    v_rcp_f32 v50, v50
    v_rcp_f32 v51, v51
    s_nop 0
    v_pk_fma_f32 v[104:105], v[16:17], v[48:49], v[104:105]
    v_pk_fma_f32 v[106:107], v[18:19], v[50:51], v[106:107]
    v_exp_f32 v48, v28
    v_exp_f32 v49, v29
    v_exp_f32 v50, v30
    v_exp_f32 v51, v31
    v_pk_add_f32 v[52:53], v[52:53], 1.0 op_sel_hi:[1,0]
    v_pk_add_f32 v[54:55], v[54:55], 1.0 op_sel_hi:[1,0]
    v_rcp_f32 v52, v52
    v_rcp_f32 v53, v53
    v_rcp_f32 v54, v54
    v_rcp_f32 v55, v55
    s_nop 0
    v_pk_fma_f32 v[104:105], v[20:21], v[52:53], v[104:105]
    v_pk_fma_f32 v[106:107], v[22:23], v[54:55], v[106:107]
    v_pk_add_f32 v[56:57], v[56:57], 1.0 op_sel_hi:[1,0]
    v_pk_add_f32 v[58:59], v[58:59], 1.0 op_sel_hi:[1,0]
    v_rcp_f32 v56, v56
    v_rcp_f32 v57, v57
    v_rcp_f32 v58, v58
    v_rcp_f32 v59, v59
    s_nop 0
    v_pk_fma_f32 v[104:105], v[24:25], v[56:57], v[104:105]
    v_pk_fma_f32 v[106:107], v[26:27], v[58:59], v[106:107]
    v_pk_add_f32 v[48:49], v[48:49], 1.0 op_sel_hi:[1,0]
    v_pk_add_f32 v[50:51], v[50:51], 1.0 op_sel_hi:[1,0]
    v_rcp_f32 v48, v48
    v_rcp_f32 v49, v49
    v_rcp_f32 v50, v50
    v_rcp_f32 v51, v51
    s_nop 0
    v_pk_fma_f32 v[104:105], v[28:29], v[48:49], v[104:105]
    v_pk_fma_f32 v[106:107], v[30:31], v[50:51], v[106:107]
    s_add_u32 s30, s30, 1
    s_cmp_lg_u32 s30, s57
    s_waitcnt vmcnt(2) lgkmcnt(0)
    s_cbranch_scc1 L_safe0
    s_branch L_loop_exit
L_seed:
    s_cmp_lg_u32 s4, 1
    s_cbranch_scc1 L_seeded
    s_mov_b64 exec, 1
    s_mov_b32 s6, 131072
    v_mov_b32 v16, s26
    v_mov_b32 v17, s27
    buffer_store_dwordx2 v[16:17], v113, s[12:15], s6 offen sc1
    s_waitcnt vmcnt(0)
    s_branch L_seeded
L_restart:
    s_mov_b64 exec, -1
    s_mov_b32 s55, 1
    s_mov_b32 s54, 0
    v_mov_b32 v108, 0
    v_mov_b32 v109, 0
    s_branch L_again
L_setflag:
    v_mov_b32 v2, 1
    ds_write_b32 v113, v2 offset:768
    s_branch L_flagged
L_more:
    s_cmp_gt_u32 s4, 12
    s_cbranch_scc1 L_more1
    ds_write_b128 v1, v[4:7] offset:40448
L_more1:
    s_add_u32 s54, s54, 12
    s_waitcnt lgkmcnt(0)
    s_barrier
L_again:
    v_add_u32 v1, v118, v117
    v_lshrrev_b32 v0, 4, v1
    v_mov_b32 v40, 65535
    v_mov_b32 v41, 65535
    v_mov_b32 v42, 65535
    v_mov_b32 v43, 65535
    v_add_u32 v33, 93696, v1
    v_and_b32 v34, 0xfc, v0
    ds_write_b128 v33, v[40:43]
    ds_write_b128 v33, v[40:43] offset:16384
    ds_write_b32 v34, v113
    s_waitcnt vmcnt(0) lgkmcnt(0)
    s_barrier
    s_branch L_round
L_skip_loop:
    ds_read_b32 v62, v56 offset:512
    ds_read_b32 v61, v56 offset:516
    s_waitcnt vmcnt(0) lgkmcnt(0)
    s_branch L_loop_done
L_noadj:
    s_mov_b32 s73, 0
    s_branch L_adj
L_compact:
    v_mov_b32 v58, v117
    s_waitcnt vmcnt(0)
    s_mov_b32 s6, 93696
    v_lshl_add_u32 v53, v49, 4, s6
    ds_write_b32 v47, v53 offset:256
    s_mov_b64 exec, s[36:37]
    ds_read_b32 v64, v28 offset:256
    s_mov_b64 exec, s[38:39]
    ds_read_b32 v65, v29 offset:256
    s_mov_b64 exec, s[40:41]
    ds_read_b32 v66, v30 offset:256
    s_mov_b64 exec, s[42:43]
    ds_read_b32 v67, v31 offset:256
    s_mov_b64 exec, s[44:45]
    ds_read_b32 v68, v32 offset:256
    s_mov_b64 exec, s[46:47]
    ds_read_b32 v69, v33 offset:256
    s_mov_b64 exec, s[48:49]
    ds_read_b32 v70, v34 offset:256
    s_mov_b64 exec, s[50:51]
    ds_read_b32 v71, v35 offset:256
    s_mov_b64 exec, s[52:53]
    ds_read_b32 v72, v36 offset:256
    s_waitcnt lgkmcnt(0)
    s_mov_b64 exec, s[36:37]
    v_add_u32 v64, v37, v64
    ds_write_b32 v64, v16
    s_mov_b64 exec, s[38:39]
    v_add_u32 v65, v38, v65
    ds_write_b32 v65, v17
    s_mov_b64 exec, s[40:41]
    v_add_u32 v66, v39, v66
    ds_write_b32 v66, v18
    s_mov_b64 exec, s[42:43]
    v_add_u32 v67, v40, v67
    ds_write_b32 v67, v20
    s_mov_b64 exec, s[44:45]
    v_add_u32 v68, v41, v68
    ds_write_b32 v68, v21
    s_mov_b64 exec, s[46:47]
    v_add_u32 v69, v42, v69
    ds_write_b32 v69, v22
    s_mov_b64 exec, s[48:49]
    v_add_u32 v70, v43, v70
    ds_write_b32 v70, v24
    s_mov_b64 exec, s[50:51]
    v_add_u32 v71, v44, v71
    ds_write_b32 v71, v25
    s_mov_b64 exec, s[52:53]
    v_add_u32 v72, v45, v72
    ds_write_b32 v72, v26
    s_mov_b64 exec, -1
    s_cmp_ge_u32 s4, 13
    s_cbranch_scc1 L_special
    v_lshl_add_u32 v55, v51, 4, s6
    v_sub_u32 v15, 0, v52
    v_and_b32 v15, 12, v15
    v_cmp_gt_u32 vcc, v15, v57
    v_add3_u32 v15, v55, v52, v57
    v_mov_b32 v64, 65535
    v_lshl_add_u32 v55, v51, 4, v58
    v_and_b32 v54, 0xffff, v54
    v_lshl_or_b32 v54, v55, 16, v54
    v_lshl_add_u32 v51, v51, 2, v57
    s_mov_b64 exec, vcc
    ds_write_b32 v15, v64
    s_mov_b64 exec, -1
L_ntab:
    v_cmp_gt_u32 vcc, v52, v58
    s_and_b64 exec, exec, vcc
    s_cbranch_execz L_tables_done
    ds_write_b32 v51, v54 offset:17408
    v_add_u32 v58, 256, v58
    v_add_u32 v51, 64, v51
    v_and_b32 v54, 0xffff7fff, v54
    v_add_u32 v54, 0x1000000, v54
    s_branch L_ntab
L_later:
    v_cmp_eq_u32 vcc, 37, v15
    s_lshl_b32 s6, s3, 2
    s_add_u32 s6, s6, 57344
    v_cndmask_b32 v38, v34, v2, vcc
    buffer_load_dword v15, v38, s[16:19], s6 offen sc1
    s_mul_i32 s7, s54, 3
    v_add_u32 v13, s7, v13
    s_lshl_b32 s6, s54, 4
    s_add_u32 s6, s6, 58176
    v_add3_u32 v35, v2, v111, s6
    s_waitcnt vmcnt(0)
    v_sub_u32_sdwa v37, v15, v13 dst_sel:DWORD dst_unused:UNUSED_PAD src0_sel:WORD_1 src1_sel:DWORD
    v_and_b32 v15, 0xffff, v15
    v_lshl_add_u32 v35, v15, 4, v35
    v_mov_b32 v32, v35
    v_mov_b32 v49, v35
    v_cmp_lt_i32 s[28:29], 0, v37
    v_cmp_lt_i32 s[30:31], 12, v37
    v_cmp_lt_i32 s[32:33], 24, v37
    s_branch L_loads
L_notyet:
    s_cmp_lg_u32 s54, 0
    s_cbranch_scc1 L_arrived
    s_add_u32 s61, s61, 1
    s_cmp_lt_u32 s61, 400000
    s_cbranch_scc1 L_reload
    s_branch L_arrived
L_code_end:
.fill 256, 4, 0xbf810000
.section .rodata,"a"
.p2align 6
.amdhsa_kernel gather_scatter__mpnn_edge_mlp__graph_kernel
.amdhsa_next_free_vgpr 128
.amdhsa_next_free_sgpr 80
.amdhsa_accum_offset 128
.amdhsa_group_segment_fixed_size 0
.amdhsa_kernarg_size 72
.amdhsa_user_sgpr_count 2
.amdhsa_user_sgpr_kernarg_segment_ptr 1
.amdhsa_system_sgpr_workgroup_id_x 1
.amdhsa_float_denorm_mode_32 3
.end_amdhsa_kernel
```
